```python
import torch

def _softmax(x, axis=-1):
    return torch.softmax(x, dim=axis)
def _gelu(x):
    return torch.nn.functional.gelu(x, approximate="tanh")
def _silu(x):
    return torch.nn.functional.silu(x)
def _sigmoid(x):
    return torch.sigmoid(x)
def _layernorm(x, axis=-1, eps=1e-5):
    m = x.mean(dim=axis, keepdim=True)
    v = x.var(dim=axis, keepdim=True, unbiased=False)
    return (x - m) / torch.sqrt(v + eps)
def _scatter_add(tgt, idx, src, axis=0):
    return tgt.clone().index_add_(axis, idx, src)
def _segment_sum(src, seg, n):
    out = torch.zeros((n,) + src.shape[1:], dtype=src.dtype)
    return out.index_add_(0, seg, src)
def _pad(x, pw):
    flat = tuple(v for pair in reversed(pw) for v in pair)
    return torch.nn.functional.pad(x, flat)

kernel_name = 'standalone__window_attn_swin_v2__vision'

def setup_inputs():

    _w = (lambda a: (lambda t: t.to(torch.bfloat16) if t.is_floating_point() else t)(torch.as_tensor(a)))
    win = 7
    H = W = (512 // win) * win
    C = 96
    nh = 4
    shift = win // 2
    coords = torch.stack(torch.meshgrid(torch.arange(win), torch.arange(win), indexing="ij"), -1).reshape(-1, 2)
    rel = coords[:, None, :] - coords[None, :, :]
    rel_idx = ((rel[..., 0] + win - 1) * (2 * win - 1) + (rel[..., 1] + win - 1)).to(torch.int64)
    tab = torch.stack(torch.meshgrid(torch.arange(1 - win, win), torch.arange(1 - win, win), indexing="ij"), -1).reshape(-1, 2).to(float)
    tab = (lambda _x: torch.sign(torch.as_tensor(_x)))(tab) * (lambda _x: torch.log1p(torch.as_tensor(_x)))(torch.abs(tab))
    img = torch.zeros((H, W), dtype=torch.int64)
    cnt = 0
    for hs in (slice(0, H - win), slice(H - win, H - shift), slice(H - shift, H)):
        for ws in (slice(0, W - win), slice(W - win, W - shift), slice(W - shift, W)):
            img[hs, ws] = cnt; cnt += 1
    mw = img.reshape(H // win, win, W // win, win).permute(0, 2, 1, 3).reshape(-1, win * win)
    mask = (mw[:, :, None] != mw[:, None, :]).to(float) * (-100.0)
    return {
        "x": _w((lambda *s: torch.randn(*s, dtype=torch.bfloat16) * 0.05)(1, H, W, C)),
        "wqkv": _w((lambda *s: torch.randn(*s, dtype=torch.bfloat16) * 1.6)(C, 3 * C)),
        "wo": _w((lambda *s: torch.randn(*s, dtype=torch.bfloat16) * 0.05)(C, C)),
        "logit_scale": _w((lambda *s: torch.randn(*s, dtype=torch.bfloat16) * 1.6)(nh)),
        "cpb_w1": _w((lambda *s: torch.randn(*s, dtype=torch.bfloat16) * 0.8)(2, 4 * nh)),
        "cpb_w2": _w((lambda *s: torch.randn(*s, dtype=torch.bfloat16) * 0.8)(4 * nh, nh)),
        "rel_coords": _w(tab),
        "rel_idx": _w(rel_idx),
        "attn_mask": _w(mask),
    }

def reference(x, wqkv, wo, logit_scale, cpb_w1, cpb_w2, rel_coords, rel_idx, attn_mask):
    B, H, W, C = x.shape
    win = 7
    nh = 4
    hd = C // nh
    shift = win // 2
    ww = win * win
    nH, nW = H // win, W // win
    xs = torch.roll(x, (-shift, -shift), (1, 2))
    xw = (lambda x, *d: x.permute(*d))(xs.reshape(B, nH, win, nW, win, C), 0, 1, 3, 2, 4, 5).reshape(B * nH * nW, ww, C)
    qkv = (lambda x, *d: x.permute(*d))((xw @ wqkv).reshape(B * nH * nW, ww, 3, nh, hd), 2, 0, 3, 1, 4)
    q, k, v = qkv[0], qkv[1], qkv[2]
    qn = q * (torch.einsum("bhqd,bhqd->bhq", q, q)[..., None] + 1e-12) ** -0.5
    kn = k * (torch.einsum("bhkd,bhkd->bhk", k, k)[..., None] + 1e-12) ** -0.5
    logits = torch.einsum("bhqd,bhkd->bhqk", qn, kn)
    tau = torch.exp(torch.clip(logit_scale, -100.0, 4.6052))
    logits = logits * tau[None, :, None, None]
    hcpb = rel_coords @ cpb_w1
    hcpb = torch.where(hcpb > 0, hcpb, hcpb * 0)
    bias_tab = 16.0 * _sigmoid(hcpb @ cpb_w2)
    bias = (lambda x, *d: x.permute(*d))(bias_tab[rel_idx], 2, 0, 1)
    logits = logits.reshape(B, nH * nW, nh, ww, ww) + bias[None, None, :, :, :] + attn_mask[None, :, None, :, :]
    p = _softmax(logits.reshape(B * nH * nW, nh, ww, ww), axis=-1)
    o = (lambda x, *d: x.permute(*d))(torch.einsum("bhqk,bhkd->bhqd", p, v), 0, 2, 1, 3).reshape(B * nH * nW, ww, C) @ wo
    o = (lambda x, *d: x.permute(*d))(o.reshape(B, nH, nW, win, win, C), 0, 1, 3, 2, 4, 5).reshape(B, H, W, C)
    o = torch.roll(o, (shift, shift), (1, 2))
    return _layernorm(o, axis=-1)
```

```asm
; @launch grid=(256,1,1) block=(256,1,1) lds=125152
.amdgcn_target "amdgcn-amd-amdhsa--gfx950"
.text
.globl standalone__window_attn_swin_v2__vision_kernel
.p2align 8
.type standalone__window_attn_swin_v2__vision_kernel,@function
standalone__window_attn_swin_v2__vision_kernel:
    s_cmp_ge_u32 s2, 256
    s_cbranch_scc1 L_END
    s_getpc_b64 s[94:95]
L_PC:
    v_lshrrev_b32 v2, 6, v0
    s_lshr_b32 s93, s2, 3
    s_lshl_b32 s93, s93, 2
    v_add_u32 v2, s93, v2
    v_and_b32 v3, 63, v0
    v_lshlrev_b32 v2, 10, v2
    v_lshl_add_u32 v2, v3, 4, v2
    s_sub_u32 s94, s94, L_PC-standalone__window_attn_swin_v2__vision_kernel
    s_subb_u32 s95, s95, 0
    v_min_u32 v2, L_CODE_END-standalone__window_attn_swin_v2__vision_kernel-16, v2
    v_mov_b32 v5, s95
    v_add_co_u32 v4, vcc, s94, v2
    s_nop 1
    v_addc_co_u32 v5, vcc, 0, v5, vcc
    global_load_dwordx4 a[244:247], v[4:5], off
    s_load_dwordx16 s[64:79], s[0:1], 0
    s_load_dwordx2 s[80:81], s[0:1], 72
    v_mov_b32 v255, v0
    v_and_b32 v254, 63, v0
    v_lshrrev_b32 v1, 6, v0
    s_and_b32 s51, s2, 7
    s_lshl_b32 s51, s51, 5
    v_readfirstlane_b32 s32, v1
    s_lshr_b32 s52, s2, 3
    s_add_u32 s38, s51, s52
    s_cmp_lt_u32 s2, 209
    s_cselect_b32 s34, 21, 20
    s_mov_b32 s33, 0
    s_mov_b32 s35, 2
    s_mov_b32 s36, 63
    s_mov_b32 s48, 0x2b0cbccc
    s_mov_b32 s40, 0x2a8cbccc
    s_mov_b32 s41, 0x2a8cbccc
    s_mov_b32 s44, 12288
    s_mov_b32 s47, 10608
    s_mov_b32 s53, 59652324
    v_lshlrev_b32 v200, 8, v254
    v_mov_b32 v201, s38
    v_mov_b32 v202, s2
    v_cmp_eq_u32 vcc, 20, v254
    s_nop 1
    v_cndmask_b32 v201, v201, v202, vcc
    v_add_u32 v200, v201, v200
    v_mul_hi_u32 v201, v200, s53
    v_mul_u32_u24 v202, 72, v201
    v_sub_u32 v202, v200, v202
    v_mul_u32_u24 v201, 686784, v201
    v_mul_u32_u24 v202, 1344, v202
    v_add_u32 v201, v201, v202
    v_add_u32 v201, 294912, v201
    v_mov_b32 v202, 1073741824
    v_cmp_gt_u32 vcc, 5184, v200
    s_nop 1
    v_cndmask_b32 v69, v202, v201, vcc
    v_and_b32 v248, 31, v254
    v_lshrrev_b32 v249, 5, v254
    v_lshlrev_b32 v233, 4, v254
    v_add_u32 v202, 0, v255
    v_mul_u32_u24 v107, 5042, v202
    v_lshrrev_b32 v107, 16, v107
    v_mad_i32_i24 v207, v107, -13, v202
    v_cmp_lt_u32 s[84:85], 11, v207
    v_cmp_lt_u32 s[86:87], 48, v107
    s_nop 3
    s_or_b64 s[84:85], s[84:85], s[86:87]
    v_min_u32 v107, 48, v107
    v_mul_u32_u24 v208, 37, v107
    v_lshrrev_b32 v208, 8, v208
    v_mul_u32_u24 v57, 96768, v208
    v_mul_u32_u24 v210, 192, v107
    v_add_u32 v57, v57, v210
    v_lshl_add_u32 v57, v207, 4, v57
    v_mov_b32 v210, 1073741824
    v_cndmask_b32_e64 v57, v57, v210, s[84:85]
    v_add_u32 v202, 256, v255
    v_mul_u32_u24 v108, 5042, v202
    v_lshrrev_b32 v108, 16, v108
    v_mad_i32_i24 v207, v108, -13, v202
    v_cmp_lt_u32 s[84:85], 11, v207
    v_cmp_lt_u32 s[86:87], 48, v108
    s_nop 3
    s_or_b64 s[84:85], s[84:85], s[86:87]
    v_min_u32 v108, 48, v108
    v_mul_u32_u24 v208, 37, v108
    v_lshrrev_b32 v208, 8, v208
    v_mul_u32_u24 v58, 96768, v208
    v_mul_u32_u24 v210, 192, v108
    v_add_u32 v58, v58, v210
    v_lshl_add_u32 v58, v207, 4, v58
    v_mov_b32 v210, 1073741824
    v_cndmask_b32_e64 v58, v58, v210, s[84:85]
    v_add_u32 v202, 512, v255
    v_mul_u32_u24 v109, 5042, v202
    v_lshrrev_b32 v109, 16, v109
    v_mad_i32_i24 v207, v109, -13, v202
    v_cmp_lt_u32 s[84:85], 11, v207
    v_cmp_lt_u32 s[86:87], 48, v109
    s_nop 3
    s_or_b64 s[84:85], s[84:85], s[86:87]
    v_min_u32 v109, 48, v109
    v_mul_u32_u24 v208, 37, v109
    v_lshrrev_b32 v208, 8, v208
    v_mul_u32_u24 v59, 96768, v208
    v_mul_u32_u24 v210, 192, v109
    v_add_u32 v59, v59, v210
    v_lshl_add_u32 v59, v207, 4, v59
    v_mov_b32 v210, 1073741824
    v_cndmask_b32_e64 v59, v59, v210, s[84:85]
    v_readlane_b32 s60, v69, 0
    v_readlane_b32 s61, v69, 1
    v_readlane_b32 s42, v69, 2
    s_mov_b32 s43, 1073741824
    s_lshl_b32 s46, s32, 10
    s_add_u32 s62, s46, 12288
    s_waitcnt lgkmcnt(0)
    v_lshlrev_b32 v209, 2, v248
    v_lshlrev_b32 v210, 16, v249
    v_sub_u32 v209, v210, v209
    s_mov_b32 s20, s76
    s_and_b32 s21, s77, 0xffff
    s_mov_b32 s22, 676
    s_mov_b32 s23, 0x00020000
    v_add_u32 v194, 672, v209
    buffer_load_dword v114, v194, s[20:23], 0 offen
    v_add_u32 v195, 544, v209
    v_add_u32 v196, 416, v209
    v_add_u32 v197, 288, v209
    v_add_u32 v198, 160, v209
    buffer_load_dword v116, v195, s[20:23], 0 offen
    v_add_u32 v199, 32, v209
    s_mov_b32 s24, s72
    s_and_b32 s25, s73, 0xffff
    s_mov_b32 s26, 64
    buffer_load_dword v118, v196, s[20:23], 0 offen
    s_mov_b32 s27, 0x00020000
    v_lshlrev_b32 v210, 1, v248
    s_lshl_b32 s63, s32, 1
    s_mov_b32 s28, s74
    buffer_load_dword v120, v197, s[20:23], 0 offen
    s_and_b32 s29, s75, 0xffff
    s_mov_b32 s30, 128
    s_mov_b32 s31, 0x00020000
    v_lshl_add_u32 v211, v249, 5, s63
    buffer_load_dword v122, v198, s[20:23], 0 offen
    s_load_dword s82, s[70:71], 0
    s_load_dword s83, s[70:71], 4
    s_mov_b32 s4, s64
    s_and_b32 s5, s65, 0xffff
    buffer_load_dword v124, v199, s[20:23], 0 offen
    s_mov_b32 s6, 50135232
    s_mov_b32 s7, 0x00020000
    v_and_b32 v220, 15, v254
    s_lshl_b32 s89, s32, 4
    buffer_load_ushort v126, v210, s[24:27], 0 offen
    v_add_u32 v220, s89, v220
    v_min_u32 v220, 49, v220
    v_mul_u32_u24 v56, 208, v220
    v_and_b32 v220, 48, v254
    buffer_load_ushort v128, v210, s[24:27], 0 offen offset:32
    v_add_u32 v56, v56, v220
    v_min_u32 v220, 12, v254
    v_lshlrev_b32 v220, 4, v220
    v_add_u32 v220, 34768, v220
    buffer_load_ushort v130, v211, s[28:31], 0 offen offset:0
    v_mov_b32 v224, 0
    v_mov_b32 v225, 0
    v_mov_b32 v226, 0
    v_mov_b32 v227, 0
    buffer_load_ushort v134, v211, s[28:31], 0 offen offset:8
    s_lshr_b32 s57, s2, 3
    ds_write_b128 v220, v[224:227]
    buffer_load_ushort v131, v211, s[28:31], 0 offen offset:16
    ds_write_b128 v220, v[224:227] offset:10608
    buffer_load_ushort v135, v211, s[28:31], 0 offen offset:24
    v_lshrrev_b32 v221, 4, v254
    s_mul_i32 s96, s57, 37
    v_lshlrev_b32 v221, 2, v221
    s_lshl_b32 s90, s32, 4
    buffer_load_ushort v132, v211, s[28:31], 0 offen offset:64
    v_mov_b32 v115, 0
    v_mov_b32 v117, 0
    v_mov_b32 v127, 0
    s_lshr_b32 s96, s96, 9
    buffer_load_ushort v136, v211, s[28:31], 0 offen offset:72
    v_add_u32 v221, s90, v221
    s_mul_i32 s96, s96, 14
    v_add_u32 v222, 0, v221
    s_sub_u32 s57, s57, s96
    buffer_load_ushort v133, v211, s[28:31], 0 offen offset:80
    v_mul_u32_u24 v224, 37, v222
    s_lshl_b32 s57, s57, 10
    s_mul_i32 s96, s32, 14336
    v_lshrrev_b32 v224, 8, v224
    buffer_load_ushort v137, v211, s[28:31], 0 offen offset:88
    s_mov_b32 m0, s46
    s_add_u32 s57, s57, s96
    v_and_b32 v223, 15, v254
    v_mul_u32_u24 v60, 96768, v224
    buffer_load_dwordx4 v57, s[4:7], s60 offen nt lds
    s_add_u32 m0, s46, 4096
    v_mul_u32_u24 v226, 192, v222
    v_cmp_lt_u32 vcc, 48, v222
    v_mul_u32_u24 v223, 12, v223
    v_add_u32 v60, v60, v226
    v_add_u32 v222, 1, v221
    s_mov_b32 s12, s66
    s_and_b32 s13, s67, 0xffff
    s_mov_b32 s14, 55296
    s_mov_b32 s15, 0x00020000
    v_mov_b32 v227, 0x80000000
    v_add_u32 v60, v60, v223
    v_mul_u32_u24 v224, 37, v222
    v_cndmask_b32 v60, v60, v227, vcc
    v_lshrrev_b32 v224, 8, v224
    v_mul_u32_u24 v61, 96768, v224
    buffer_load_dwordx4 v58, s[4:7], s60 offen nt lds
    s_add_u32 m0, s46, 8192
    v_mul_u32_u24 v226, 192, v222
    v_cmp_lt_u32 vcc, 48, v222
    v_add_u32 v61, v61, v226
    v_cmp_gt_u32 s[84:85], 32, v254
    v_add_u32 v61, v61, v223
    v_add_u32 v222, 2, v221
    s_add_u32 s97, s96, 14336
    v_add_u32 v53, 32, v248
    v_cndmask_b32 v61, v61, v227, vcc
    v_mul_u32_u24 v224, 37, v222
    v_mov_b32 v219, 0x3f80
    v_cmp_lt_u32 s[58:59], 48, v53
    v_lshrrev_b32 v224, 8, v224
    v_mul_u32_u24 v226, 192, v222
    v_cmp_lt_u32 vcc, 48, v222
    buffer_load_dwordx4 v59, s[4:7], s60 offen nt lds
    s_add_u32 m0, s57, 45792
    v_lshrrev_b32 v212, 3, v255
    v_cndmask_b32_e64 v64, 0, v219, s[84:85]
    v_mul_u32_u24 v62, 96768, v224
    v_add_u32 v222, 3, v221
    v_mov_b32 v119, 0
    v_mov_b32 v121, 0
    v_lshrrev_b32 v217, 3, v212
    v_mov_b32 v219, 50
    v_mul_u32_u24 v224, 37, v222
    v_lshlrev_b32 v217, 8, v217
    v_and_b32 v218, 7, v212
    v_cndmask_b32_e64 v219, v53, v219, s[58:59]
    v_add_u32 v62, v62, v226
    v_lshrrev_b32 v224, 8, v224
    v_and_b32 v213, 7, v255
    buffer_load_dwordx4 v233, s[12:15], s57 offen lds
    s_add_u32 s57, s57, 1024
    s_cmp_eq_u32 s57, s97
    s_cselect_b32 s57, s96, s57
    s_add_u32 m0, s57, 45792
    v_lshl_add_u32 v217, v218, 1, v217
    s_mul_i32 s88, s32, 48
    v_mul_u32_u24 v219, 208, v219
    v_add_u32 v62, v62, v223
    v_mul_u32_u24 v63, 96768, v224
    v_mul_u32_u24 v226, 192, v222
    v_mul_u32_u24 v214, 192, v212
    v_mul_u32_u24 v215, 24, v213
    v_lshl_add_u32 v217, v213, 5, v217
    s_add_u32 s88, s88, 24576
    v_lshl_add_u32 v219, v249, 3, v219
    v_cndmask_b32 v62, v62, v227, vcc
    buffer_load_dwordx4 v233, s[12:15], s57 offen lds
    v_add_u32 v63, v63, v226
    v_add_u32 v234, v214, v215
    v_add_u32 v247, 103136, v217
    v_add_u32 v55, s88, v219
    v_add_u32 v63, v63, v223
    v_cmp_lt_u32 vcc, 48, v222
    s_add_u32 s57, s57, 1024
    s_cmp_eq_u32 s57, s97
    s_cselect_b32 s57, s96, s57
    s_add_u32 m0, s57, 45792
    v_mov_b32 v123, 0
    v_mov_b32 v125, 0
    s_cmp_ge_u32 s32, 2
    s_waitcnt lgkmcnt(0)
    s_cselect_b32 s82, s83, s82
    s_bitcmp1_b32 s32, 0
    s_cselect_b32 s92, 0, 16
    buffer_load_dwordx4 v233, s[12:15], s57 offen lds
    s_add_u32 s57, s57, 1024
    s_cmp_eq_u32 s57, s97
    s_cselect_b32 s57, s96, s57
    s_add_u32 m0, s57, 45792
    s_lshl_b32 s82, s82, s92
    v_cmp_lt_u32 s[58:59], 31, v254
    s_and_b32 s82, s82, 0xffff0000
    v_mov_b32 v252, s82
    v_min_f32 v252, 0x40930000, v252
    v_max_f32 v252, 0xc2c80000, v252
    v_mul_f32 v252, 0x3fb8aa3b, v252
    v_exp_f32 v252, v252
    v_mov_b32 v245, 0x42140000
    v_cvt_pk_bf16_f32 v252, 0, v252
    v_add_f32 v253, 0x41800000, v252
    buffer_load_dwordx4 v233, s[12:15], s57 offen lds
    s_add_u32 s57, s57, 1024
    s_cmp_eq_u32 s57, s97
    s_cselect_b32 s57, s96, s57
    s_add_u32 m0, s57, 45792
    v_cmp_lt_f32 s[94:95], v245, v252
    v_mul_f32 v253, 0x3fb8aa3b, v253
    v_add_f32 v253, 0xc2200000, v253
    v_mov_b32 v245, 0
    s_mul_i32 s93, s32, 768
    v_and_b32 v76, 31, v254
    v_cndmask_b32_e64 v253, v253, v245, s[94:95]
    s_add_u32 s93, s93, 121568
    v_add_u32 v78, 0, v76
    v_lshl_add_u32 v244, v254, 2, s93
    v_min_u32 v78, 48, v78
    v_mul_u32_u24 v79, 37, v78
    buffer_load_dwordx4 v233, s[12:15], s57 offen lds
    s_add_u32 s57, s57, 1024
    s_cmp_eq_u32 s57, s97
    s_cselect_b32 s57, s96, s57
    s_add_u32 m0, s57, 45792
    v_lshrrev_b32 v79, 8, v79
    v_mul_u32_u24 v79, 6, v79
    s_mul_i32 s63, s32, 768
    v_add_u32 v78, v78, v79
    v_lshrrev_b32 v77, 5, v254
    s_add_u32 s63, s63, 121904
    v_lshlrev_b32 v78, 2, v78
    v_sub_u32 v78, s63, v78
    v_mul_u32_u24 v79, 40, v77
    v_lshl_add_u32 v81, v77, 4, v78
    v_add_u32 v82, v78, v79
    s_sub_u32 s51, s2, 64
    buffer_load_dwordx4 v233, s[12:15], s57 offen lds
    s_add_u32 s57, s57, 1024
    s_cmp_eq_u32 s57, s97
    s_cselect_b32 s57, s96, s57
    s_add_u32 m0, s57, 45792
    v_add_u32 v78, 32, v76
    s_sub_u32 s55, s51, 72
    v_min_u32 v78, 48, v78
    s_cmp_lt_u32 s51, 72
    s_cselect_b32 s52, s51, 72
    s_cselect_b32 s45, 1, 2
    s_cselect_b32 s55, 72, s55
    v_mul_u32_u24 v79, 37, v78
    v_lshrrev_b32 v79, 8, v79
    v_mul_u32_u24 v79, 6, v79
    v_bfe_u32 v228, v254, 2, 2
    v_lshlrev_b32 v112, 3, v254
    buffer_load_dwordx4 v233, s[12:15], s57 offen lds
    s_add_u32 s57, s57, 1024
    s_cmp_eq_u32 s57, s97
    s_cselect_b32 s57, s96, s57
    s_add_u32 m0, s57, 45792
    v_add_u32 v78, v78, v79
    v_lshl_add_u32 v228, v249, 3, v228
    s_mul_i32 s91, s32, 48
    v_mov_b32 v110, 0xf149f2ca
    v_mov_b32 v111, 0xf149f2ca
    v_add_u32 v112, 124640, v112
    s_mul_i32 s39, s52, 686784
    s_mul_i32 s55, s55, 1344
    v_lshlrev_b32 v78, 2, v78
    v_mul_u32_u24 v228, 576, v228
    s_add_u32 s91, s91, 45792
    s_cmp_eq_u32 s51, 144
    s_cselect_b32 s45, 3, s45
    buffer_load_dwordx4 v233, s[12:15], s57 offen lds
    s_add_u32 s39, s39, s55
    v_sub_u32 v78, s63, v78
    v_mul_u32_u24 v79, 40, v77
    s_add_u32 s57, s57, 1024
    v_add_u32 v228, s91, v228
    s_add_u32 s39, s39, 294912
    v_lshrrev_b32 v92, 4, v254
    v_add_u32 v84, v78, v79
    s_cmp_eq_u32 s57, s97
    s_cselect_b32 s57, s96, s57
    s_cmp_lt_u32 s51, 145
    s_cselect_b32 s45, s45, 0
    s_cselect_b32 s39, s39, 0
    s_cselect_b32 s37, 18, -1
    s_cselect_b32 s56, 20, 62
    v_lshlrev_b32 v92, 2, v92
    s_lshl_b32 s91, s32, 4
    v_mov_b32 v79, 124640
    v_add_u32 v92, s91, v92
    s_add_u32 m0, s57, 45792
    v_add_u32 v93, 0, v92
    v_mul_u32_u24 v94, 37, v93
    buffer_load_dwordx4 v233, s[12:15], s57 offen lds
    v_lshrrev_b32 v94, 8, v94
    s_bitcmp1_b32 s45, 1
    s_cselect_b32 s53, 50135232, 0
    v_cmp_le_u32 s[90:91], 4, v94
    v_mov_b32 v86, s53
    v_mad_i32_i24 v95, v94, -7, v93
    v_cndmask_b32_e64 v97, 0, v86, s[90:91]
    s_add_u32 s57, s57, 1024
    s_bitcmp1_b32 s45, 0
    s_cselect_b32 s54, 98112, 0
    v_cmp_le_u32 s[90:91], 4, v95
    s_cmp_eq_u32 s57, s97
    s_cselect_b32 s57, s96, s57
    v_add_u32 v96, s39, v60
    v_add_u32 v93, 1, v92
    v_mov_b32 v87, s54
    v_sub_u32 v96, v96, v97
    v_mul_u32_u24 v94, 37, v93
    s_add_u32 m0, s57, 45792
    v_cndmask_b32_e64 v97, 0, v87, s[90:91]
    v_lshrrev_b32 v94, 8, v94
    v_cmp_le_u32 s[90:91], 4, v94
    buffer_load_dwordx4 v233, s[12:15], s57 offen lds
    v_sub_u32 v96, v96, v97
    v_mad_i32_i24 v95, v94, -7, v93
    v_cndmask_b32_e64 v97, 0, v86, s[90:91]
    v_accvgpr_write_b32 a212, v96
    v_cmp_le_u32 s[90:91], 4, v95
    s_add_u32 s57, s57, 1024
    v_add_u32 v96, s39, v61
    v_add_u32 v93, 2, v92
    s_cmp_eq_u32 s57, s97
    s_cselect_b32 s57, s96, s57
    v_sub_u32 v96, v96, v97
    v_mul_u32_u24 v94, 37, v93
    v_cndmask_b32_e64 v97, 0, v87, s[90:91]
    v_lshrrev_b32 v94, 8, v94
    s_add_u32 m0, s57, 45792
    v_cmp_le_u32 s[90:91], 4, v94
    buffer_load_dwordx4 v233, s[12:15], s57 offen lds
    v_sub_u32 v96, v96, v97
    v_mad_i32_i24 v95, v94, -7, v93
    v_cndmask_b32_e64 v97, 0, v86, s[90:91]
    v_accvgpr_write_b32 a213, v96
    v_cmp_le_u32 s[90:91], 4, v95
    v_add_u32 v96, s39, v62
    v_add_u32 v93, 3, v92
    v_sub_u32 v96, v96, v97
    v_mul_u32_u24 v94, 37, v93
    s_add_u32 s57, s57, 1024
    v_cndmask_b32_e64 v97, 0, v87, s[90:91]
    v_lshrrev_b32 v94, 8, v94
    s_cmp_eq_u32 s57, s97
    s_cselect_b32 s57, s96, s57
    v_cmp_le_u32 s[90:91], 4, v94
    s_add_u32 m0, s57, 45792
    v_sub_u32 v96, v96, v97
    v_mad_i32_i24 v95, v94, -7, v93
    v_cndmask_b32_e64 v97, 0, v86, s[90:91]
    buffer_load_dwordx4 v233, s[12:15], s57 offen lds
    v_cndmask_b32 v63, v63, v227, vcc
    v_accvgpr_write_b32 a214, v96
    v_cmp_le_u32 s[90:91], 4, v95
    v_add_u32 v96, s39, v63
    v_sub_u32 v96, v96, v97
    v_mbcnt_lo_u32_b32 v94, -1, 0
    v_cndmask_b32_e64 v97, 0, v87, s[90:91]
    s_waitcnt vmcnt(23)
    v_lshl_or_b32 v126, v128, 16, v126
    v_mbcnt_hi_u32_b32 v94, -1, v94
    s_add_u32 s57, s57, 1024
    v_mfma_f32_32x32x8_bf16 v[142:157], v[126:127], v[114:115], 0
    v_sub_u32 v96, v96, v97
    v_cmp_lt_u32 vcc, 31, v94
    s_cmp_eq_u32 s57, s97
    s_cselect_b32 s57, s96, s57
    v_accvgpr_write_b32 a215, v96
    v_mov_b32 v96, 0xC310C310
    v_mfma_f32_32x32x8_bf16 v[194:209], v[126:127], v[116:117], 0
    s_waitcnt vmcnt(21)
    v_lshl_or_b32 v130, v134, 16, v130
    v_mov_b32 v97, 0xBE8ABE8A
    s_add_u32 m0, s57, 45792
    v_and_b32 v95, 31, v94
    v_cndmask_b32 v96, v96, v97, vcc
    v_cvt_pk_bf16_f32 v138, v142, v143
    v_cvt_pk_bf16_f32 v139, v144, v145
    v_cvt_pk_bf16_f32 v140, v146, v147
    v_cvt_pk_bf16_f32 v141, v148, v149
    v_mfma_f32_32x32x8_bf16 v[142:157], v[126:127], v[118:119], 0
    v_pk_max_i16 v138, v138, 0
    v_pk_max_i16 v139, v139, 0
    v_cvt_pk_bf16_f32 v72, v194, v195
    v_cvt_pk_bf16_f32 v73, v196, v197
    v_cvt_pk_bf16_f32 v74, v198, v199
    v_cvt_pk_bf16_f32 v75, v200, v201
    v_mfma_f32_32x32x8_bf16 v[194:209], v[126:127], v[120:121], 0
    s_waitcnt vmcnt(19)
    v_lshl_or_b32 v131, v135, 16, v131
    v_pk_max_i16 v140, v140, 0
    v_pk_max_i16 v141, v141, 0
    v_pk_max_i16 v72, v72, 0
    v_pk_max_i16 v73, v73, 0
    v_pk_max_i16 v74, v74, 0
    v_pk_max_i16 v75, v75, 0
    v_add_u32 v97, 0, v95
    buffer_load_dwordx4 v233, s[12:15], s57 offen lds
    s_waitcnt vmcnt(18)
    v_lshl_or_b32 v132, v136, 16, v132
    v_mul_u32_u24 v54, 208, v248
    v_min_u32 v97, 48, v97
    v_lshl_add_u32 v54, v249, 3, v54
    v_mul_u32_u24 v88, 37, v107
    v_mul_u32_u24 v98, 37, v97
    v_add_u32 v54, s88, v54
    v_lshrrev_b32 v88, 8, v88
    v_lshrrev_b32 v98, 8, v98
    v_cmp_le_u32 s[88:89], 4, v88
    s_waitcnt vmcnt(16)
    v_lshl_or_b32 v133, v137, 16, v133
    v_cmp_le_u32 vcc, 4, v98
    s_add_u32 s57, s57, 1024
    v_mfma_f32_32x32x16_bf16 v[178:193], v[130:133], v[138:141], 0
    v_cvt_pk_bf16_f32 v138, v142, v143
    v_cvt_pk_bf16_f32 v139, v144, v145
    v_cvt_pk_bf16_f32 v140, v146, v147
    v_cvt_pk_bf16_f32 v141, v148, v149
    v_pk_max_i16 v138, v138, 0
    v_pk_max_i16 v139, v139, 0
    v_mfma_f32_32x32x16_bf16 v[210:225], v[130:133], v[72:75], 0
    v_cvt_pk_bf16_f32 v72, v194, v195
    v_cvt_pk_bf16_f32 v73, v196, v197
    v_cvt_pk_bf16_f32 v74, v198, v199
    v_cvt_pk_bf16_f32 v75, v200, v201
    v_pk_max_i16 v140, v140, 0
    v_pk_max_i16 v141, v141, 0
    v_mfma_f32_32x32x8_bf16 v[142:157], v[126:127], v[122:123], 0
    v_pk_max_i16 v72, v72, 0
    v_pk_max_i16 v73, v73, 0
    v_pk_max_i16 v74, v74, 0
    v_pk_max_i16 v75, v75, 0
    v_mov_b32 v237, v178
    v_mov_b32 v238, v210
    v_mfma_f32_32x32x8_bf16 v[194:209], v[126:127], v[124:125], 0
    v_cndmask_b32_e64 v237, v237, v238, s[58:59]
    v_cvt_pk_bf16_f32 v237, 0, v237
    v_mul_f32 v237, 0xbfb8aa3b, v237
    v_exp_f32 v237, v237
    v_mad_i32_i24 v89, v88, -7, v107
    v_mfma_f32_32x32x16_bf16 v[178:193], v[130:133], v[138:141], 0
    v_cvt_pk_bf16_f32 v138, v142, v143
    v_cvt_pk_bf16_f32 v139, v144, v145
    v_cvt_pk_bf16_f32 v140, v146, v147
    v_cvt_pk_bf16_f32 v141, v148, v149
    v_pk_max_i16 v138, v138, 0
    v_pk_max_i16 v139, v139, 0
    v_mfma_f32_32x32x16_bf16 v[210:225], v[130:133], v[72:75], 0
    v_cvt_pk_bf16_f32 v72, v194, v195
    v_cvt_pk_bf16_f32 v73, v196, v197
    v_cvt_pk_bf16_f32 v74, v198, v199
    v_cvt_pk_bf16_f32 v75, v200, v201
    v_pk_max_i16 v140, v140, 0
    v_pk_max_i16 v141, v141, 0
    v_pk_max_i16 v72, v72, 0
    v_pk_max_i16 v73, v73, 0
    v_pk_max_i16 v74, v74, 0
    v_pk_max_i16 v75, v75, 0
    v_mov_b32 v239, v178
    v_mfma_f32_32x32x16_bf16 v[178:193], v[130:133], v[138:141], 0
    v_mov_b32 v240, v210
    v_cndmask_b32_e64 v239, v239, v240, s[58:59]
    v_add_f32 v237, 1.0, v237
    v_cvt_pk_bf16_f32 v239, 0, v239
    v_rcp_f32 v237, v237
    v_mfma_f32_32x32x16_bf16 v[210:225], v[130:133], v[72:75], 0
    v_mul_f32 v239, 0xbfb8aa3b, v239
    v_exp_f32 v239, v239
    v_cvt_pk_bf16_f32 v237, 0, v237
    v_mul_f32 v237, 0x41b8aa3b, v237
    v_add_f32 v239, 1.0, v239
    v_sub_f32 v237, v237, v253
    v_mov_b32 v241, v178
    v_rcp_f32 v239, v239
    ds_write_b32 v244, v237 offset:0
    v_cvt_pk_bf16_f32 v239, 0, v239
    v_mul_f32 v239, 0x41b8aa3b, v239
    v_sub_f32 v239, v239, v253
    v_mov_b32 v242, v210
    v_cndmask_b32_e64 v241, v241, v242, s[58:59]
    v_cvt_pk_bf16_f32 v241, 0, v241
    v_mul_f32 v241, 0xbfb8aa3b, v241
    v_exp_f32 v241, v241
    ds_write_b32 v244, v239 offset:256
    v_add_f32 v241, 1.0, v241
    v_rcp_f32 v241, v241
    v_cmp_lt_u32 s[58:59], 16, v76
    v_cvt_pk_bf16_f32 v241, 0, v241
    v_mul_f32 v241, 0x41b8aa3b, v241
    v_sub_f32 v241, v241, v253
    ds_write_b32 v244, v241 offset:512
    ds_write_b64 v112, v[110:111]
    v_cndmask_b32_e64 v84, v84, v79, s[58:59]
    ds_read_b32 v24, v82 offset:336
    ds_read_b32 v50, v84 offset:336
    s_cmp_eq_u32 s57, s97
    s_cselect_b32 s57, s96, s57
    v_cndmask_b32_e64 v91, 0, v86, s[88:89]
    v_mad_i32_i24 v99, v98, -7, v97
    v_cndmask_b32_e64 v100, 0, 1, vcc
    v_cmp_le_u32 s[88:89], 4, v89
    v_cmp_le_u32 vcc, 4, v99
    s_add_u32 m0, s57, 45792
    v_add_u32 v90, s39, v57
    v_sub_u32 v90, v90, v91
    v_mul_u32_u24 v88, 37, v108
    s_lshr_b32 s51, s45, 1
    buffer_load_dwordx4 v233, s[12:15], s57 offen lds
    v_cndmask_b32_e64 v91, 0, v87, s[88:89]
    v_lshrrev_b32 v88, 8, v88
    v_and_b32 v100, s51, v100
    v_cndmask_b32_e64 v101, 0, 16, vcc
    v_cmp_le_u32 s[88:89], 4, v88
    s_and_b32 s52, s45, 1
    v_cmp_eq_u32 vcc, 0, v100
    v_add_u32 v97, 32, v95
    v_mov_b32 v103, 0xffff
    v_mul_u32_u24 v101, s52, v101
    v_min_u32 v97, 48, v97
    s_mov_b32 s16, s68
    s_and_b32 s17, s69, 0xffff
    s_mov_b32 s18, 18432
    s_mov_b32 s19, 0x00020000
    v_sub_u32 v90, v90, v91
    v_lshlrev_b32 v102, v101, v103
    v_mul_u32_u24 v98, 37, v97
    buffer_load_dwordx4 a[224:227], v234, s[16:19], 0 offen
    v_mad_i32_i24 v89, v88, -7, v108
    v_cndmask_b32_e64 v91, 0, v86, s[88:89]
    v_cndmask_b32_e64 v100, 0, v102, vcc
    v_cndmask_b32_e64 v101, v102, 0, vcc
    v_lshrrev_b32 v98, 8, v98
    v_accvgpr_write_b32 a216, v90
    v_cmp_le_u32 s[88:89], 4, v89
    v_cmp_le_u32 vcc, 4, v98
    v_add_u32 v90, s39, v58
    v_mov_b32 v104, 0x3f803f80
    v_sub_u32 v90, v90, v91
    v_mul_u32_u24 v88, 37, v109
    v_and_b32 v105, v104, v100
    v_bfi_b32 v107, v100, 0, v96
    v_add_u32 v235, 6144, v234
    v_cndmask_b32_e64 v91, 0, v87, s[88:89]
    v_lshrrev_b32 v88, 8, v88
    v_mad_i32_i24 v99, v98, -7, v97
    buffer_load_dwordx2 a[228:229], v234, s[16:19], 0 offen offset:16
    v_cndmask_b32_e64 v100, 0, 1, vcc
    v_cmp_le_u32 s[88:89], 4, v88
    v_cmp_le_u32 vcc, 4, v99
    v_sub_u32 v90, v90, v91
    buffer_load_dwordx4 a[230:233], v235, s[16:19], 0 offen
    v_and_b32 v106, v104, v101
    v_bfi_b32 v108, v101, 0, v96
    v_and_b32 v229, 3, v254
    v_mad_i32_i24 v89, v88, -7, v109
    v_cndmask_b32_e64 v91, 0, v86, s[88:89]
    v_and_b32 v100, s51, v100
    v_cndmask_b32_e64 v101, 0, 16, vcc
    v_add_u32 v236, 12288, v234
    v_bfe_u32 v230, v254, 4, 1
    v_lshrrev_b32 v232, 1, v229
    v_lshl_add_u32 v83, v77, 4, v78
    v_accvgpr_write_b32 a217, v90
    v_cmp_le_u32 s[88:89], 4, v89
    v_cmp_eq_u32 vcc, 0, v100
    v_and_b32 v231, 1, v229
    v_lshl_add_u32 v232, v230, 1, v232
    v_cndmask_b32_e64 v83, v83, v79, s[58:59]
    v_add_u32 v90, s39, v59
    buffer_load_dwordx2 a[234:235], v235, s[16:19], 0 offen offset:16
    v_mul_u32_u24 v101, s52, v101
    v_cmp_le_u32 s[86:87], 24, v248
    v_mul_u32_u24 v231, 24, v231
    v_lshlrev_b32 v232, 3, v232
    buffer_load_dwordx4 a[236:239], v236, s[16:19], 0 offen
    v_cmp_lt_u32 s[58:59], 31, v254
    v_sub_u32 v90, v90, v91
    v_lshlrev_b32 v102, v101, v103
    v_min_u32 v53, 49, v53
    v_add3_u32 v231, v228, v231, v232
    v_cndmask_b32_e64 v91, 0, v87, s[88:89]
    v_accvgpr_write_b32 a204, v105
    v_accvgpr_write_b32 a205, v106
    v_accvgpr_write_b32 a208, v107
    v_accvgpr_write_b32 a209, v108
    v_cndmask_b32_e64 v100, 0, v102, vcc
    v_cndmask_b32_e64 v101, v102, 0, vcc
    ds_read_b32 v0, v81 offset:0
    ds_read_b32 v1, v81 offset:4
    ds_read_b32 v2, v81 offset:8
    buffer_load_dwordx2 a[240:241], v236, s[16:19], 0 offen offset:16
    ds_read_b32 v3, v82 offset:12
    ds_read_b32 v4, v81 offset:56
    ds_read_b32 v5, v81 offset:60
    ds_read_b32 v6, v82 offset:64
    ds_read_b32 v7, v82 offset:68
    ds_read_b32 v8, v81 offset:112
    ds_read_b32 v9, v82 offset:116
    ds_read_b32 v10, v82 offset:120
    ds_read_b32 v11, v82 offset:124
    ds_read_b32 v12, v82 offset:168
    ds_read_b32 v13, v82 offset:172
    ds_read_b32 v14, v82 offset:176
    ds_read_b32 v15, v82 offset:180
    ds_read_b32 v16, v82 offset:224
    ds_read_b32 v17, v82 offset:228
    ds_read_b32 v18, v82 offset:232
    ds_read_b32 v19, v81 offset:260
    ds_read_b32 v20, v82 offset:280
    ds_read_b32 v21, v82 offset:284
    ds_read_b32 v22, v81 offset:312
    ds_read_b32 v23, v81 offset:316
    ds_read_b32 v26, v83 offset:0
    ds_read_b32 v27, v83 offset:4
    ds_read_b32 v28, v83 offset:8
    ds_read_b32 v29, v84 offset:12
    ds_read_b32 v30, v83 offset:56
    ds_read_b32 v31, v83 offset:60
    ds_read_b32 v32, v84 offset:64
    ds_read_b32 v33, v84 offset:68
    ds_read_b32 v34, v83 offset:112
    ds_read_b32 v35, v84 offset:116
    ds_read_b32 v36, v84 offset:120
    ds_read_b32 v37, v84 offset:124
    ds_read_b32 v38, v84 offset:168
    ds_read_b32 v39, v84 offset:172
    ds_read_b32 v40, v84 offset:176
    ds_read_b32 v41, v84 offset:180
    ds_read_b32 v42, v84 offset:224
    ds_read_b32 v43, v84 offset:228
    ds_read_b32 v44, v84 offset:232
    ds_read_b32 v45, v83 offset:260
    ds_read_b32 v46, v84 offset:280
    ds_read_b32 v47, v84 offset:284
    ds_read_b32 v48, v83 offset:312
    ds_read_b32 v49, v83 offset:316
    v_mul_u32_u24 v52, 208, v248
    v_mul_u32_u24 v53, 208, v53
    v_lshlrev_b32 v230, 5, v230
    v_lshlrev_b32 v232, 3, v229
    v_mul_f32 v252, 0x3fb8aa3b, v252
    v_mov_b32 v68, 1.0
    s_cmp_lg_u64 s[94:95], 0
    s_cselect_b32 s49, 1, 0
    v_mov_b32 v80, 0xf149f2ca
    v_sub_u32 v90, v90, v91
    v_and_b32 v105, v104, v100
    v_and_b32 v106, v104, v101
    v_bfi_b32 v107, v100, 0, v96
    v_bfi_b32 v108, v101, 0, v96
    s_mov_b32 s8, s80
    s_and_b32 s9, s81, 0xffff
    s_mov_b32 s10, 50135232
    s_mov_b32 s11, 0x00020000
    v_mov_b32 v65, 0
    v_mov_b32 v67, 0
    v_mov_b32 v71, 0
    v_mov_b32 v251, 0
    v_cndmask_b32_e64 v66, 0, v64, s[86:87]
    v_lshl_add_u32 v52, v249, 4, v52
    v_lshl_add_u32 v53, v249, 4, v53
    v_add_u32 v56, 24576, v56
    v_add3_u32 v232, v228, v230, v232
    v_cndmask_b32_e64 v68, v68, v252, s[84:85]
    s_waitcnt lgkmcnt(15)
    v_cndmask_b32_e64 v24, v24, v80, s[58:59]
    v_cndmask_b32_e64 v50, v50, v80, s[58:59]
    v_mov_b32 v25, 0
    v_mov_b32 v51, 0
    v_writelane_b32 v69, 0, s56
    v_accvgpr_write_b32 a218, v90
    v_accvgpr_write_b32 a206, v105
    v_accvgpr_write_b32 a207, v106
    v_accvgpr_write_b32 a210, v107
    v_accvgpr_write_b32 a211, v108
    s_waitcnt vmcnt(6) lgkmcnt(0)
    s_barrier
    v_mfma_f32_32x32x8_bf16 v[210:225], v[64:65], v[66:67], 0
    s_mov_b32 m0, s62
    s_waitcnt vmcnt(5)
    v_accvgpr_read_b32 v226, a224
    v_accvgpr_read_b32 v227, a225
    v_and_b32 v233, 0xffff0000, v226
    v_lshlrev_b32 v234, 16, v227
    v_and_b32 v235, 0xffff0000, v227
    v_mfma_f32_32x32x8_bf16 v[146:161], v[64:65], v[66:67], 0
    buffer_load_dwordx4 v57, s[4:7], s61 offen nt lds
    ds_read_b64_tr_b16 a[0:1], v231 offset:0
    ds_read_b64_tr_b16 a[24:25], v231 offset:192
    ds_read_b64_tr_b16 a[48:49], v232 offset:384
    ds_read_b64_tr_b16 a[2:3], v231 offset:2304
    ds_read_b64_tr_b16 a[26:27], v231 offset:2496
    ds_read_b64_tr_b16 a[50:51], v232 offset:2688
    ds_read_b64_tr_b16 a[4:5], v231 offset:9216
    ds_read_b64_tr_b16 a[28:29], v231 offset:9408
    ds_read_b64_tr_b16 a[52:53], v232 offset:9600
    ds_read_b64_tr_b16 a[6:7], v231 offset:11520
    ds_read_b64_tr_b16 a[30:31], v231 offset:11712
    ds_read_b64_tr_b16 a[54:55], v232 offset:11904
    ds_read_b64_tr_b16 a[8:9], v231 offset:18432
    ds_read_b64_tr_b16 a[32:33], v231 offset:18624
    ds_read_b64_tr_b16 a[56:57], v232 offset:18816
    ds_read_b64_tr_b16 a[10:11], v231 offset:20736
    ds_read_b64_tr_b16 a[34:35], v231 offset:20928
    ds_read_b64_tr_b16 a[58:59], v232 offset:21120
    ds_read_b64_tr_b16 a[12:13], v231 offset:27648
    ds_read_b64_tr_b16 a[36:37], v231 offset:27840
    ds_read_b64_tr_b16 a[60:61], v232 offset:28032
    ds_read_b64_tr_b16 a[14:15], v231 offset:29952
    ds_read_b64_tr_b16 a[38:39], v231 offset:30144
    ds_read_b64_tr_b16 a[62:63], v232 offset:30336
    ds_read_b64_tr_b16 a[16:17], v231 offset:36864
    ds_read_b64_tr_b16 a[40:41], v231 offset:37056
    ds_read_b64_tr_b16 a[64:65], v232 offset:37248
    ds_read_b64_tr_b16 a[18:19], v231 offset:39168
    ds_read_b64_tr_b16 a[42:43], v231 offset:39360
    ds_read_b64_tr_b16 a[66:67], v232 offset:39552
    ds_read_b64_tr_b16 a[20:21], v231 offset:46080
    ds_read_b64_tr_b16 a[44:45], v231 offset:46272
    ds_read_b64_tr_b16 a[68:69], v232 offset:46464
    ds_read_b64_tr_b16 a[22:23], v231 offset:48384
    ds_read_b64_tr_b16 a[46:47], v231 offset:48576
    ds_read_b64_tr_b16 a[70:71], v232 offset:48768
    ds_read_b128 a[180:183], v53 offset:96
    ds_read_b128 a[184:187], v53 offset:128
    ds_read_b128 a[188:191], v53 offset:160
    ds_read_b128 a[168:171], v53 offset:0
    ds_read_b128 a[172:175], v53 offset:32
    ds_read_b128 a[176:179], v53 offset:64
    s_mov_b64 exec, s[86:87]
    s_waitcnt lgkmcnt(15)
    v_accvgpr_write_b32 a48, 0
    v_accvgpr_write_b32 a49, 0
    v_accvgpr_write_b32 a50, 0
    v_accvgpr_write_b32 a51, 0
    v_accvgpr_write_b32 a0, 0
    v_accvgpr_write_b32 a1, 0
    v_accvgpr_write_b32 a2, 0
    v_accvgpr_write_b32 a3, 0
    v_accvgpr_write_b32 a24, 0
    v_accvgpr_write_b32 a25, 0
    v_accvgpr_write_b32 a26, 0
    v_accvgpr_write_b32 a27, 0
    s_mov_b64 exec, -1
    s_mov_b64 exec, s[86:87]
    v_accvgpr_write_b32 a52, 0
    v_accvgpr_write_b32 a53, 0
    v_accvgpr_write_b32 a54, 0
    v_accvgpr_write_b32 a55, 0
    v_accvgpr_write_b32 a4, 0
    v_accvgpr_write_b32 a5, 0
    v_accvgpr_write_b32 a6, 0
    v_accvgpr_write_b32 a7, 0
    v_accvgpr_write_b32 a28, 0
    v_accvgpr_write_b32 a29, 0
    v_accvgpr_write_b32 a30, 0
    v_accvgpr_write_b32 a31, 0
    s_mov_b64 exec, -1
    s_mov_b64 exec, s[86:87]
    v_accvgpr_write_b32 a56, 0
    v_accvgpr_write_b32 a57, 0
    v_accvgpr_write_b32 a58, 0
    v_accvgpr_write_b32 a59, 0
    v_accvgpr_write_b32 a8, 0
    v_accvgpr_write_b32 a9, 0
    v_accvgpr_write_b32 a10, 0
    v_accvgpr_write_b32 a11, 0
    v_accvgpr_write_b32 a32, 0
    v_accvgpr_write_b32 a33, 0
    v_accvgpr_write_b32 a34, 0
    v_accvgpr_write_b32 a35, 0
    s_mov_b64 exec, -1
    s_mov_b64 exec, s[86:87]
    v_accvgpr_write_b32 a60, 0
    v_accvgpr_write_b32 a61, 0
    v_accvgpr_write_b32 a62, 0
    v_accvgpr_write_b32 a63, 0
    v_accvgpr_write_b32 a12, 0
    v_accvgpr_write_b32 a13, 0
    v_accvgpr_write_b32 a14, 0
    v_accvgpr_write_b32 a15, 0
    v_accvgpr_write_b32 a36, 0
    v_accvgpr_write_b32 a37, 0
    v_accvgpr_write_b32 a38, 0
    v_accvgpr_write_b32 a39, 0
    s_mov_b64 exec, -1
    s_add_u32 m0, s62, 4096
    v_lshlrev_b32 v232, 16, v226
    buffer_load_dwordx4 v58, s[4:7], s61 offen nt lds
    s_add_u32 m0, s62, 8192
    v_accvgpr_read_b32 v228, a226
    s_mov_b64 exec, s[86:87]
    v_accvgpr_write_b32 a64, 0
    v_accvgpr_write_b32 a65, 0
    s_waitcnt lgkmcnt(0)
    v_accvgpr_write_b32 a66, 0
    v_accvgpr_write_b32 a67, 0
    v_accvgpr_write_b32 a16, 0
    v_accvgpr_write_b32 a17, 0
    v_accvgpr_write_b32 a18, 0
    v_accvgpr_write_b32 a19, 0
    v_accvgpr_write_b32 a40, 0
    v_accvgpr_write_b32 a41, 0
    v_accvgpr_write_b32 a42, 0
    v_accvgpr_write_b32 a43, 0
    s_mov_b64 exec, -1
    v_mfma_f32_32x32x16_bf16 v[130:145], a[24:27], a[168:171], 0
    buffer_load_dwordx4 v59, s[4:7], s61 offen nt lds
    v_lshlrev_b32 v236, 16, v228
    s_mov_b64 exec, s[86:87]
    v_accvgpr_write_b32 a68, 0
    v_accvgpr_write_b32 a69, 0
    v_accvgpr_write_b32 a70, 0
    v_accvgpr_write_b32 a71, 0
    v_accvgpr_write_b32 a20, 0
    v_accvgpr_write_b32 a21, 0
    v_accvgpr_write_b32 a22, 0
    v_accvgpr_write_b32 a23, 0
    v_accvgpr_write_b32 a44, 0
    v_accvgpr_write_b32 a45, 0
    v_accvgpr_write_b32 a46, 0
    v_accvgpr_write_b32 a47, 0
    s_mov_b64 exec, -1
    v_mfma_f32_32x32x16_bf16 v[130:145], a[28:31], a[172:175], v[130:145]
    v_and_b32 v237, 0xffff0000, v228
    v_accvgpr_read_b32 v229, a227
    v_add_f32 v244, v232, v233
    v_add_f32 v245, v234, v235
    v_lshlrev_b32 v238, 16, v229
    v_and_b32 v239, 0xffff0000, v229
    v_mfma_f32_32x32x16_bf16 v[130:145], a[32:35], a[176:179], v[130:145]
    s_waitcnt vmcnt(7)
    v_accvgpr_read_b32 v230, a228
    v_add_f32 v244, v244, v236
    v_add_f32 v245, v245, v237
    v_lshlrev_b32 v240, 16, v230
    v_and_b32 v241, 0xffff0000, v230
    v_accvgpr_read_b32 v231, a229
    v_mfma_f32_32x32x16_bf16 v[130:145], a[36:39], a[180:183], v[130:145]
    v_add_f32 v244, v244, v238
    v_add_f32 v245, v245, v239
    v_lshlrev_b32 v242, 16, v231
    v_and_b32 v243, 0xffff0000, v231
    v_add_f32 v244, v244, v240
    v_add_f32 v245, v245, v241
    v_mfma_f32_32x32x16_bf16 v[130:145], a[40:43], a[184:187], v[130:145]
    v_add_f32 v244, v244, v242
    v_add_f32 v245, v245, v243
    v_add_f32 v244, v244, v245
    v_add_u32 v53, s44, v53
    ds_read_b128 a[144:147], v52 offset:0
    ds_read_b128 a[148:151], v52 offset:32
    ds_read_b128 a[152:155], v52 offset:64
    v_mfma_f32_32x32x16_bf16 v[130:145], a[44:47], a[188:191], v[130:145]
    v_add_f32_dpp v245, v244, v244 quad_perm:[1,0,3,2] row_mask:0xf bank_mask:0xf
    ds_read_b128 a[156:159], v52 offset:96
    ds_read_b128 a[160:163], v52 offset:128
    ds_read_b128 a[164:167], v52 offset:160
    v_mfma_f32_32x32x16_bf16 v[114:129], a[0:3], a[168:171], 0
    v_add_f32_dpp v244, v245, v245 quad_perm:[2,3,0,1] row_mask:0xf bank_mask:0xf
    v_add_u32 v52, s44, v52
    s_nop 0
    v_add_f32_dpp v245, v244, v244 row_half_mirror row_mask:0xf bank_mask:0xf
    v_mul_f32 v244, 0xbc2aaaab, v245
    v_add_f32 v232, v232, v244
    v_mfma_f32_32x32x16_bf16 v[114:129], a[4:7], a[172:175], v[114:129]
    v_add_f32 v233, v233, v244
    v_fma_f32 v253, v130, v130, s48
    v_fmac_f32 v253, v131, v131
    v_fmac_f32 v253, v132, v132
    v_fmac_f32 v253, v133, v133
    v_fmac_f32 v253, v134, v134
    v_mfma_f32_32x32x16_bf16 v[114:129], a[8:11], a[176:179], v[114:129]
    v_fmac_f32 v253, v135, v135
    v_fmac_f32 v253, v136, v136
    v_fmac_f32 v253, v137, v137
    v_fmac_f32 v253, v138, v138
    v_fmac_f32 v253, v139, v139
    v_fmac_f32 v253, v140, v140
    v_mfma_f32_32x32x16_bf16 v[114:129], a[12:15], a[180:183], v[114:129]
    v_fmac_f32 v253, v141, v141
    v_add_f32 v234, v234, v244
    v_add_f32 v235, v235, v244
    v_add_f32 v236, v236, v244
    v_add_f32 v237, v237, v244
    v_cvt_pk_bf16_f32 v226, v232, v233
    v_mfma_f32_32x32x16_bf16 v[114:129], a[16:19], a[184:187], v[114:129]
    v_cvt_pk_bf16_f32 v227, v234, v235
    v_cvt_pk_bf16_f32 v228, v236, v237
    v_add_f32 v238, v238, v244
    v_add_f32 v239, v239, v244
    v_add_f32 v240, v240, v244
    v_add_f32 v241, v241, v244
    v_mfma_f32_32x32x16_bf16 v[114:129], a[20:23], a[188:191], v[114:129]
    v_add_f32 v242, v242, v244
    v_add_f32 v243, v243, v244
    v_cvt_pk_bf16_f32 v229, v238, v239
    v_cvt_pk_bf16_f32 v230, v240, v241
    v_cvt_pk_bf16_f32 v231, v242, v243
    ds_write_b16 v247, v226 offset:0
    ds_write_b16_d16_hi v247, v226 offset:1024
    ds_write_b16 v247, v227 offset:2048
    ds_write_b16_d16_hi v247, v227 offset:3072
    ds_write_b16 v247, v228 offset:4096
    ds_write_b16_d16_hi v247, v228 offset:5120
    s_waitcnt lgkmcnt(6)
    v_mfma_f32_32x32x16_bf16 v[210:225], a[144:147], a[48:51], v[210:225]
    v_fma_f32 v252, v114, v114, s48
    v_fmac_f32 v252, v115, v115
    v_fmac_f32 v252, v116, v116
    v_fmac_f32 v252, v117, v117
    v_fmac_f32 v252, v118, v118
    v_fmac_f32 v252, v119, v119
    v_mfma_f32_32x32x16_bf16 v[210:225], a[148:151], a[52:55], v[210:225]
    v_fmac_f32 v252, v120, v120
    v_fmac_f32 v252, v121, v121
    v_fmac_f32 v252, v122, v122
    v_fmac_f32 v252, v123, v123
    v_fmac_f32 v252, v124, v124
    v_fmac_f32 v252, v125, v125
    v_mfma_f32_32x32x16_bf16 v[210:225], a[152:155], a[56:59], v[210:225]
    s_waitcnt vmcnt(6)
    v_accvgpr_read_b32 v226, a230
    v_permlane32_swap_b32 v252, v253
    v_add_f32 v252, v252, v253
    v_rsq_f32 v252, v252
    v_mfma_f32_32x32x16_bf16 v[210:225], a[156:159], a[60:63], v[210:225]
    v_mul_f32 v252, v252, v68
    v_mov_b32 v253, v252
    v_accvgpr_read_b32 v227, a231
    v_lshlrev_b32 v232, 16, v226
    v_permlane32_swap_b32 v252, v253
    v_mfma_f32_32x32x16_bf16 v[210:225], a[160:163], a[64:67], v[210:225]
    v_and_b32 v233, 0xffff0000, v226
    v_lshlrev_b32 v234, 16, v227
    v_and_b32 v235, 0xffff0000, v227
    v_accvgpr_read_b32 v228, a232
    v_mul_f32 v114, v114, v252
    v_mul_f32 v115, v115, v252
    v_mfma_f32_32x32x16_bf16 v[210:225], a[164:167], a[68:71], v[210:225]
    v_mul_f32 v116, v116, v252
    v_mul_f32 v117, v117, v252
    v_mul_f32 v118, v118, v252
    v_mul_f32 v119, v119, v252
    v_mul_f32 v120, v120, v252
    v_mul_f32 v121, v121, v252
    v_mfma_f32_32x32x16_bf16 v[194:209], a[24:27], a[144:147], 0
    v_mul_f32 v122, v122, v252
    v_mul_f32 v123, v123, v252
    v_mul_f32 v124, v124, v252
    v_mul_f32 v125, v125, v252
    v_mul_f32 v130, v130, v253
    v_mul_f32 v131, v131, v253
    v_mfma_f32_32x32x16_bf16 v[194:209], a[28:31], a[148:151], v[194:209]
    v_mul_f32 v132, v132, v253
    v_mul_f32 v133, v133, v253
    v_mul_f32 v134, v134, v253
    v_mul_f32 v135, v135, v253
    v_mul_f32 v136, v136, v253
    v_mul_f32 v137, v137, v253
    v_mfma_f32_32x32x16_bf16 v[194:209], a[32:35], a[152:155], v[194:209]
    v_mul_f32 v138, v138, v253
    v_mul_f32 v139, v139, v253
    v_mul_f32 v140, v140, v253
    v_mul_f32 v141, v141, v253
    v_lshlrev_b32 v236, 16, v228
    v_and_b32 v237, 0xffff0000, v228
    v_mfma_f32_32x32x16_bf16 v[194:209], a[36:39], a[156:159], v[194:209]
    v_add_f32 v244, v232, v233
    v_add_f32 v245, v234, v235
    v_add_f32 v244, v244, v236
    v_add_f32 v245, v245, v237
    v_cvt_pk_bf16_f32 v78, v114, v115
    v_cvt_pk_bf16_f32 v79, v116, v117
    v_mfma_f32_32x32x16_bf16 v[194:209], a[40:43], a[160:163], v[194:209]
    v_cvt_pk_bf16_f32 v80, v118, v119
    v_cvt_pk_bf16_f32 v81, v120, v121
    v_cvt_pk_bf16_f32 v82, v122, v123
    v_cvt_pk_bf16_f32 v83, v124, v125
    v_cvt_pk_bf16_f32 v90, v130, v131
    v_cvt_pk_bf16_f32 v91, v132, v133
    v_mfma_f32_32x32x16_bf16 v[194:209], a[44:47], a[164:167], v[194:209]
    v_cvt_pk_bf16_f32 v92, v134, v135
    v_cvt_pk_bf16_f32 v93, v136, v137
    v_cvt_pk_bf16_f32 v94, v138, v139
    v_cvt_pk_bf16_f32 v95, v140, v141
    v_cvt_pk_bf16_f32 v96, v210, v211
    v_cvt_pk_bf16_f32 v97, v212, v213
    v_mfma_f32_32x32x16_bf16 v[178:193], a[0:3], a[144:147], 0
    v_cvt_pk_bf16_f32 v98, v214, v215
    v_cvt_pk_bf16_f32 v99, v216, v217
    v_cvt_pk_bf16_f32 v100, v218, v219
    v_cvt_pk_bf16_f32 v101, v220, v221
    v_cvt_pk_bf16_f32 v102, v222, v223
    v_fma_f32 v111, v194, v194, s48
    v_mfma_f32_32x32x16_bf16 v[178:193], a[4:7], a[148:151], v[178:193]
    v_fmac_f32 v111, v195, v195
    v_fmac_f32 v111, v196, v196
    v_fmac_f32 v111, v197, v197
    v_fmac_f32 v111, v198, v198
    v_fmac_f32 v111, v199, v199
    v_fmac_f32 v111, v200, v200
    v_mfma_f32_32x32x16_bf16 v[178:193], a[8:11], a[152:155], v[178:193]
    v_fmac_f32 v111, v201, v201
    v_fmac_f32 v111, v202, v202
    v_fmac_f32 v111, v203, v203
    v_fmac_f32 v111, v204, v204
    v_fmac_f32 v111, v205, v205
    v_cvt_pk_bf16_f32 v103, v224, v225
    v_mfma_f32_32x32x16_bf16 v[178:193], a[12:15], a[156:159], v[178:193]
    ds_write_b16 v247, v229 offset:16
    ds_write_b16_d16_hi v247, v229 offset:1040
    ds_write_b16 v247, v230 offset:2064
    ds_write_b16_d16_hi v247, v230 offset:3088
    ds_write_b16 v247, v231 offset:4112
    ds_write_b16_d16_hi v247, v231 offset:5136
    v_mfma_f32_32x32x16_bf16 v[178:193], a[16:19], a[160:163], v[178:193]
    v_accvgpr_read_b32 v229, a233
    v_lshlrev_b32 v238, 16, v229
    v_and_b32 v239, 0xffff0000, v229
    s_waitcnt vmcnt(5)
    v_accvgpr_read_b32 v230, a234
    v_lshlrev_b32 v240, 16, v230
    v_and_b32 v241, 0xffff0000, v230
    v_mfma_f32_32x32x16_bf16 v[178:193], a[20:23], a[164:167], v[178:193]
    v_accvgpr_read_b32 v231, a235
    v_add_f32 v244, v244, v238
    v_add_f32 v245, v245, v239
    v_lshlrev_b32 v242, 16, v231
    v_and_b32 v243, 0xffff0000, v231
    v_add_f32 v244, v244, v240
    v_mfma_f32_32x32x16_bf16 v[146:161], a[168:171], a[48:51], v[146:161]
    v_add_f32 v245, v245, v241
    v_add_f32 v244, v244, v242
    v_add_f32 v245, v245, v243
    v_add_f32 v244, v244, v245
    s_nop 0
    v_fma_f32 v110, v178, v178, s48
    v_mfma_f32_32x32x16_bf16 v[146:161], a[172:175], a[52:55], v[146:161]
    v_add_f32_dpp v245, v244, v244 quad_perm:[1,0,3,2] row_mask:0xf bank_mask:0xf
    v_fmac_f32 v110, v179, v179
    v_fmac_f32 v110, v180, v180
    v_add_f32_dpp v244, v245, v245 quad_perm:[2,3,0,1] row_mask:0xf bank_mask:0xf
    v_fmac_f32 v110, v181, v181
    v_fmac_f32 v110, v182, v182
    v_mfma_f32_32x32x16_bf16 v[146:161], a[176:179], a[56:59], v[146:161]
    v_add_f32_dpp v245, v244, v244 row_half_mirror row_mask:0xf bank_mask:0xf
    v_mul_f32 v244, 0xbc2aaaab, v245
    v_add_f32 v232, v232, v244
    v_add_f32 v233, v233, v244
    v_add_f32 v234, v234, v244
    v_add_f32 v235, v235, v244
    v_mfma_f32_32x32x16_bf16 v[146:161], a[180:183], a[60:63], v[146:161]
    v_add_f32 v236, v236, v244
    v_add_f32 v237, v237, v244
    v_cvt_pk_bf16_f32 v226, v232, v233
    v_cvt_pk_bf16_f32 v227, v234, v235
    v_cvt_pk_bf16_f32 v228, v236, v237
    v_add_f32 v238, v238, v244
    v_mfma_f32_32x32x16_bf16 v[146:161], a[184:187], a[64:67], v[146:161]
    v_add_f32 v239, v239, v244
    v_add_f32 v240, v240, v244
    v_add_f32 v241, v241, v244
    v_add_f32 v242, v242, v244
    v_add_f32 v243, v243, v244
    v_cvt_pk_bf16_f32 v229, v238, v239
    v_mfma_f32_32x32x16_bf16 v[146:161], a[188:191], a[68:71], v[146:161]
    ds_write_b16 v247, v226 offset:6144
    ds_write_b16_d16_hi v247, v226 offset:7168
    ds_write_b16 v247, v227 offset:8192
    ds_write_b16_d16_hi v247, v227 offset:9216
    ds_write_b16 v247, v228 offset:10240
    ds_write_b16_d16_hi v247, v228 offset:11264
    v_cvt_pk_bf16_f32 v230, v240, v241
    v_cvt_pk_bf16_f32 v231, v242, v243
    s_waitcnt vmcnt(4)
    v_accvgpr_read_b32 v226, a236
    v_accvgpr_read_b32 v227, a237
    ds_write_b16 v247, v229 offset:6160
    ds_write_b16_d16_hi v247, v229 offset:7184
    ds_write_b16 v247, v230 offset:8208
    ds_write_b16_d16_hi v247, v230 offset:9232
    ds_write_b16 v247, v231 offset:10256
    ds_write_b16_d16_hi v247, v231 offset:11280
    v_lshlrev_b32 v232, 16, v226
    v_and_b32 v233, 0xffff0000, v226
    v_lshlrev_b32 v234, 16, v227
    v_and_b32 v235, 0xffff0000, v227
    v_accvgpr_read_b32 v228, a238
    v_lshlrev_b32 v236, 16, v228
    v_and_b32 v237, 0xffff0000, v228
    v_accvgpr_read_b32 v229, a239
    v_add_f32 v244, v232, v233
    v_add_f32 v245, v234, v235
    v_lshlrev_b32 v238, 16, v229
    v_and_b32 v239, 0xffff0000, v229
    s_waitcnt vmcnt(3)
    v_accvgpr_read_b32 v230, a240
    v_add_f32 v244, v244, v236
    v_add_f32 v245, v245, v237
    v_lshlrev_b32 v240, 16, v230
    v_and_b32 v241, 0xffff0000, v230
    v_accvgpr_read_b32 v231, a241
    v_add_f32 v244, v244, v238
    v_add_f32 v245, v245, v239
    v_lshlrev_b32 v242, 16, v231
    v_and_b32 v243, 0xffff0000, v231
    v_add_f32 v244, v244, v240
    v_add_f32 v245, v245, v241
    v_add_f32 v244, v244, v242
    v_add_f32 v245, v245, v243
    v_add_f32 v244, v244, v245
    v_cvt_pk_bf16_f32 v104, v146, v147
    v_cvt_pk_bf16_f32 v105, v148, v149
    v_add_f32_dpp v245, v244, v244 quad_perm:[1,0,3,2] row_mask:0xf bank_mask:0xf
    v_cvt_pk_bf16_f32 v106, v150, v151
    v_cvt_pk_bf16_f32 v107, v152, v153
    v_add_f32_dpp v244, v245, v245 quad_perm:[2,3,0,1] row_mask:0xf bank_mask:0xf
    v_cvt_pk_bf16_f32 v108, v154, v155
    v_cvt_pk_bf16_f32 v109, v156, v157
    v_add_f32_dpp v245, v244, v244 row_half_mirror row_mask:0xf bank_mask:0xf
    v_mul_f32 v244, 0xbc2aaaab, v245
    v_add_f32 v232, v232, v244
    v_add_f32 v233, v233, v244
    v_add_f32 v234, v234, v244
    v_add_f32 v235, v235, v244
    v_add_f32 v236, v236, v244
    v_add_f32 v237, v237, v244
    v_add_f32 v238, v238, v244
    v_add_f32 v239, v239, v244
    v_add_f32 v240, v240, v244
    v_add_f32 v241, v241, v244
    v_add_f32 v242, v242, v244
    v_add_f32 v243, v243, v244
    v_cvt_pk_bf16_f32 v226, v232, v233
    v_cvt_pk_bf16_f32 v227, v234, v235
    v_cvt_pk_bf16_f32 v228, v236, v237
    v_cvt_pk_bf16_f32 v229, v238, v239
    v_cvt_pk_bf16_f32 v230, v240, v241
    v_cvt_pk_bf16_f32 v231, v242, v243
    ds_write_b16 v247, v226 offset:12288
    ds_write_b16_d16_hi v247, v226 offset:13312
    ds_write_b16 v247, v227 offset:14336
    ds_write_b16_d16_hi v247, v227 offset:15360
    ds_write_b16 v247, v228 offset:16384
    ds_write_b16_d16_hi v247, v228 offset:17408
    ds_write_b16 v247, v229 offset:12304
    ds_write_b16_d16_hi v247, v229 offset:13328
    ds_write_b16 v247, v230 offset:14352
    ds_write_b16_d16_hi v247, v230 offset:15376
    ds_write_b16 v247, v231 offset:16400
    ds_write_b16_d16_hi v247, v231 offset:17424
    v_fmac_f32 v110, v183, v183
    v_fmac_f32 v110, v184, v184
    v_fmac_f32 v110, v185, v185
    v_fmac_f32 v110, v186, v186
    v_fmac_f32 v110, v187, v187
    v_fmac_f32 v110, v188, v188
    v_fmac_f32 v110, v189, v189
    s_nop 1
    v_permlane32_swap_b32 v110, v111
    v_add_f32 v110, v110, v111
    v_rsq_f32 v110, v110
    s_nop 0
    v_mul_f32 v110, v110, v68
    v_mov_b32 v111, v110
    s_nop 1
    v_permlane32_swap_b32 v110, v111
    v_mul_f32 v178, v178, v110
    v_mul_f32 v179, v179, v110
    v_cvt_pk_bf16_f32 v72, v178, v179
    v_mul_f32 v180, v180, v110
    v_mul_f32 v181, v181, v110
    v_cvt_pk_bf16_f32 v73, v180, v181
    v_mul_f32 v182, v182, v110
    v_mul_f32 v183, v183, v110
    v_cvt_pk_bf16_f32 v74, v182, v183
    v_mul_f32 v184, v184, v110
    v_mul_f32 v185, v185, v110
    v_cvt_pk_bf16_f32 v75, v184, v185
    v_mul_f32 v186, v186, v110
    v_mul_f32 v187, v187, v110
    v_cvt_pk_bf16_f32 v76, v186, v187
    v_mul_f32 v188, v188, v110
    v_mul_f32 v189, v189, v110
    v_cvt_pk_bf16_f32 v77, v188, v189
    v_mul_f32 v194, v194, v111
    v_mul_f32 v195, v195, v111
    v_cvt_pk_bf16_f32 v84, v194, v195
    v_mul_f32 v196, v196, v111
    v_mul_f32 v197, v197, v111
    v_cvt_pk_bf16_f32 v85, v196, v197
    v_mul_f32 v198, v198, v111
    v_mul_f32 v199, v199, v111
    v_cvt_pk_bf16_f32 v86, v198, v199
    v_mul_f32 v200, v200, v111
    v_mul_f32 v201, v201, v111
    v_cvt_pk_bf16_f32 v87, v200, v201
    v_mul_f32 v202, v202, v111
    v_mul_f32 v203, v203, v111
    v_cvt_pk_bf16_f32 v88, v202, v203
    v_mul_f32 v204, v204, v111
    v_mul_f32 v205, v205, v111
    v_cvt_pk_bf16_f32 v89, v204, v205
    s_sub_u32 s44, 0, s44
    s_waitcnt vmcnt(0) lgkmcnt(0)
    s_barrier
    v_mbcnt_lo_u32_b32 v243, -1, 0
    v_mbcnt_hi_u32_b32 v243, -1, v243
    v_lshlrev_b32 v243, 4, v243
    v_add_u32 v243, 103136, v243
    ds_read_b128 a[72:75], v243 offset:0
    ds_read_b128 a[76:79], v243 offset:1024
    ds_read_b128 a[80:83], v243 offset:2048
    ds_read_b128 a[84:87], v243 offset:3072
    ds_read_b128 a[88:91], v243 offset:4096
    ds_read_b128 a[92:95], v243 offset:5120
    ds_read_b128 a[96:99], v243 offset:6144
    ds_read_b128 a[100:103], v243 offset:7168
    ds_read_b128 a[104:107], v243 offset:8192
    ds_read_b128 a[108:111], v243 offset:9216
    ds_read_b128 a[112:115], v243 offset:10240
    ds_read_b128 a[116:119], v243 offset:11264
    ds_read_b128 a[120:123], v243 offset:12288
    ds_read_b128 a[124:127], v243 offset:13312
    ds_read_b128 a[128:131], v243 offset:14336
    ds_read_b128 a[132:135], v243 offset:15360
    ds_read_b128 a[136:139], v243 offset:16384
    ds_read_b128 a[140:143], v243 offset:17408
    s_waitcnt lgkmcnt(0)
    s_cmp_lg_u32 s49, 0
    s_cbranch_scc1 S_LOOP
.p2align 3
F_LOOP:
    s_cmp_eq_u32 s33, s37
    s_cbranch_scc1 F1_SWAP
F1_SWAP_RET:
    v_mfma_f32_32x32x16_bf16 v[114:129], v[84:87], v[72:75], v[0:15]
    s_mov_b32 m0, s46
    s_add_u32 s33, s33, 1
    s_add_u32 s35, s35, 1
    s_add_u32 s36, s36, 1
    s_and_b32 s36, s36, 63
    buffer_load_dwordx4 v57, s[4:7], s42 offen nt lds
    v_mfma_f32_32x32x8_bf16 v[114:129], v[88:89], v[76:77], v[114:129]
    s_add_u32 m0, s46, 4096
    ds_read_b128 a[144:147], v52 offset:0
    ds_read_b128 a[148:151], v52 offset:32
    ds_read_b128 a[152:155], v52 offset:64
    v_mfma_f32_32x32x16_bf16 v[162:177], v[90:93], v[78:81], v[42:57]
    buffer_load_dwordx4 v58, s[4:7], s42 offen nt lds
    s_add_u32 m0, s46, 8192
    ds_read_b128 a[156:159], v52 offset:96
    ds_read_b128 a[160:163], v52 offset:128
    ds_read_b128 a[164:167], v52 offset:160
    v_mfma_f32_32x32x16_bf16 v[146:161], v[84:87], v[78:81], v[26:41]
    buffer_load_dwordx4 v59, s[4:7], s42 offen nt lds
    v_add_u32 v56, s47, v56
    ds_read_b128 a[192:195], v56 offset:0
    ds_read_b128 a[196:199], v56 offset:64
    ds_read_b128 a[200:203], v56 offset:128
    v_mfma_f32_32x32x8_bf16 v[146:161], v[88:89], v[82:83], v[146:161]
    ds_read_b128 a[168:171], v53 offset:0
    ds_read_b128 a[172:175], v53 offset:32
    ds_read_b128 a[176:179], v53 offset:64
    v_exp_f32_e64 v114, v114
    v_mfma_f32_32x32x16_bf16 v[130:145], v[90:93], v[72:75], v[16:31]
    v_exp_f32 v115, v115
    v_exp_f32 v116, v116
    v_exp_f32_e64 v117, v117
    v_mfma_f32_32x32x8_bf16 v[130:145], v[94:95], v[76:77], v[130:145]
    v_cvt_pk_bf16_f32 v114, v114, v115
    v_exp_f32 v118, v118
    v_exp_f32 v119, v119
    v_cvt_pk_bf16_f32 v115, v116, v117
    v_mfma_f32_32x32x8_bf16 v[162:177], v[94:95], v[82:83], v[162:177]
    ds_read_b128 a[180:183], v53 offset:96
    ds_read_b128 a[184:187], v53 offset:128
    ds_read_b128 a[188:191], v53 offset:160
    v_exp_f32 v120, v120
    v_exp_f32 v121, v121
    v_exp_f32 v122, v122
    s_waitcnt lgkmcnt(11)
    v_mfma_f32_32x32x16_bf16 v[178:193], a[0:3], a[144:147], 0
    v_exp_f32 v123, v123
    v_exp_f32 v124, v124
    v_exp_f32_e64 v125, v125
    v_mfma_f32_32x32x16_bf16 v[178:193], a[4:7], a[148:151], v[178:193]
    v_exp_f32 v126, v126
    v_exp_f32 v127, v127
    v_exp_f32_e64 v128, v128
    v_mfma_f32_32x32x16_bf16 v[178:193], a[8:11], a[152:155], v[178:193]
    v_exp_f32 v129, v129
    v_exp_f32 v130, v130
    v_exp_f32_e64 v131, v131
    v_mfma_f32_32x32x16_bf16 v[178:193], a[12:15], a[156:159], v[178:193]
    v_exp_f32 v132, v132
    v_exp_f32 v133, v133
    v_exp_f32 v134, v134
    s_waitcnt lgkmcnt(3)
    v_mfma_f32_32x32x16_bf16 v[178:193], a[16:19], a[160:163], v[178:193]
    v_exp_f32 v135, v135
    v_exp_f32 v136, v136
    v_exp_f32_e64 v137, v137
    v_mfma_f32_32x32x16_bf16 v[178:193], a[20:23], a[164:167], v[178:193]
    v_cvt_pk_bf16_f32 v116, v118, v119
    v_cvt_pk_bf16_f32 v117, v120, v121
    v_cvt_pk_bf16_f32 v118, v122, v123
    v_cvt_pk_bf16_f32 v119, v124, v125
    v_cvt_pk_bf16_f32 v120, v126, v127
    v_cvt_pk_bf16_f32 v121, v128, v129
    v_mfma_f32_32x32x16_bf16 v[194:209], a[24:27], a[144:147], 0
    v_cvt_pk_bf16_f32 v142, v130, v131
    v_cvt_pk_bf16_f32 v143, v132, v133
    v_cvt_pk_bf16_f32 v144, v134, v135
    v_cvt_pk_bf16_f32 v145, v136, v137
    v_exp_f32_e64 v138, v138
    v_mfma_f32_32x32x16_bf16 v[194:209], a[28:31], a[148:151], v[194:209]
    v_fma_f32 v110, v178, v178, s48
    v_fmac_f32 v110, v179, v179
    v_fmac_f32 v110, v180, v180
    v_fmac_f32 v110, v181, v181
    v_fmac_f32 v110, v182, v182
    v_fmac_f32_e64 v110, v183, v183
    v_mfma_f32_32x32x16_bf16 v[194:209], a[32:35], a[152:155], v[194:209]
    v_fmac_f32 v110, v184, v184
    v_fmac_f32 v110, v185, v185
    v_fmac_f32 v110, v186, v186
    v_fmac_f32 v110, v187, v187
    v_fmac_f32 v110, v188, v188
    v_fmac_f32 v110, v189, v189
    v_mfma_f32_32x32x16_bf16 v[194:209], a[36:39], a[156:159], v[194:209]
    v_cvt_pk_bf16_f32 v70, v138, 0
    v_exp_f32 v146, v146
    v_exp_f32 v147, v147
    v_readlane_b32 s42, v69, s35
    v_mfma_f32_32x32x16_bf16 v[194:209], a[40:43], a[160:163], v[194:209]
    v_exp_f32 v148, v148
    v_exp_f32 v149, v149
    v_exp_f32_e64 v150, v150
    v_mfma_f32_32x32x16_bf16 v[194:209], a[44:47], a[164:167], v[194:209]
    v_exp_f32 v151, v151
    v_exp_f32 v152, v152
    v_exp_f32_e64 v153, v153
    v_mfma_f32_16x16x32_bf16 v[210:213], a[192:195], a[72:75], 0
    v_cvt_pk_bf16_f32 v146, v146, v147
    v_cvt_pk_bf16_f32 v147, v148, v149
    v_mfma_f32_16x16x32_bf16 v[214:217], a[192:195], a[76:79], 0
    v_exp_f32_e64 v154, v154
    v_mfma_f32_16x16x32_bf16 v[218:221], a[192:195], a[80:83], 0
    v_exp_f32_e64 v155, v155
    v_mfma_f32_16x16x32_bf16 v[222:225], a[192:195], a[84:87], 0
    v_exp_f32_e64 v156, v156
    v_mfma_f32_16x16x32_bf16 v[226:229], a[192:195], a[88:91], 0
    v_fma_f32 v111, v194, v194, s48
    v_fmac_f32_e64 v111, v195, v195
    v_mfma_f32_16x16x32_bf16 v[230:233], a[192:195], a[92:95], 0
    v_fmac_f32 v111, v196, v196
    v_fmac_f32 v111, v197, v197
    v_mfma_f32_16x16x32_bf16 v[210:213], a[196:199], a[96:99], v[210:213]
    v_fmac_f32 v111, v198, v198
    v_fmac_f32 v111, v199, v199
    v_mfma_f32_16x16x32_bf16 v[214:217], a[196:199], a[100:103], v[214:217]
    v_fmac_f32 v111, v200, v200
    v_fmac_f32 v111, v201, v201
    v_mfma_f32_16x16x32_bf16 v[218:221], a[196:199], a[104:107], v[218:221]
    v_fmac_f32 v111, v202, v202
    v_fmac_f32 v111, v203, v203
    v_mfma_f32_16x16x32_bf16 v[222:225], a[196:199], a[108:111], v[222:225]
    v_fmac_f32 v111, v204, v204
    v_fmac_f32 v111, v205, v205
    v_mfma_f32_16x16x32_bf16 v[226:229], a[196:199], a[112:115], v[226:229]
    v_exp_f32_e64 v157, v157
    v_mfma_f32_16x16x32_bf16 v[230:233], a[196:199], a[116:119], v[230:233]
    v_permlane32_swap_b32 v110, v111
    v_mfma_f32_16x16x32_bf16 v[210:213], a[200:203], a[120:123], v[210:213]
    v_add_f32 v110, v110, v111
    v_cvt_pk_bf16_f32 v148, v150, v151
    v_mfma_f32_16x16x32_bf16 v[214:217], a[200:203], a[124:127], v[214:217]
    v_rsq_f32_e64 v110, v110
    v_mfma_f32_16x16x32_bf16 v[218:221], a[200:203], a[128:131], v[218:221]
    v_mul_f32 v110, v110, v68
    v_mov_b32 v111, v110
    v_mfma_f32_16x16x32_bf16 v[222:225], a[200:203], a[132:135], v[222:225]
    v_exp_f32_e64 v158, v158
    v_mfma_f32_16x16x32_bf16 v[226:229], a[200:203], a[136:139], v[226:229]
    v_permlane32_swap_b32 v110, v111
    v_mfma_f32_16x16x32_bf16 v[230:233], a[200:203], a[140:143], v[230:233]
    v_mul_f32 v194, v194, v111
    v_mul_f32_e64 v195, v195, v111
    v_mfma_f32_32x32x16_bf16 v[122:137], v[96:99], v[114:117], 0
    v_mul_f32 v196, v196, v111
    v_mul_f32 v197, v197, v111
    v_mul_f32 v198, v198, v111
    v_mul_f32 v199, v199, v111
    v_mul_f32 v200, v200, v111
    v_mul_f32 v201, v201, v111
    v_mul_f32 v202, v202, v111
    v_mul_f32 v203, v203, v111
    v_mul_f32 v204, v204, v111
    v_mul_f32 v205, v205, v111
    v_pk_mul_f32 v[234:235], v[210:211], v[210:211]
    v_pk_mul_f32 v[236:237], v[212:213], v[212:213]
    v_pk_fma_f32 v[234:235], v[214:215], v[214:215], v[234:235]
    v_pk_fma_f32 v[236:237], v[216:217], v[216:217], v[236:237]
    v_pk_fma_f32 v[234:235], v[218:219], v[218:219], v[234:235]
    v_pk_fma_f32 v[236:237], v[220:221], v[220:221], v[236:237]
    v_pk_fma_f32 v[234:235], v[222:223], v[222:223], v[234:235]
    v_pk_fma_f32 v[236:237], v[224:225], v[224:225], v[236:237]
    v_pk_fma_f32 v[234:235], v[226:227], v[226:227], v[234:235]
    v_pk_fma_f32 v[236:237], v[228:229], v[228:229], v[236:237]
    v_pk_fma_f32 v[234:235], v[230:231], v[230:231], v[234:235]
    v_pk_fma_f32 v[236:237], v[232:233], v[232:233], v[236:237]
    v_mfma_f32_32x32x16_bf16 v[122:137], v[100:103], v[118:121], v[122:137]
    v_cvt_pk_bf16_f32 v84, v194, v195
    v_cvt_pk_bf16_f32 v85, v196, v197
    v_cvt_pk_bf16_f32 v86, v198, v199
    v_cvt_pk_bf16_f32 v87, v200, v201
    v_cvt_pk_bf16_f32 v88, v202, v203
    v_cvt_pk_bf16_f32 v89, v204, v205
    v_mfma_f32_32x32x16_bf16 v[194:209], a[24:27], a[168:171], 0
    v_add_f32_dpp v242, v234, v234 row_ror:8 row_mask:0xf bank_mask:0x3
    v_add_f32_dpp v243, v236, v236 row_ror:8 row_mask:0xf bank_mask:0x3
    v_mul_f32_e64 v178, v178, v110
    v_add_f32_dpp v242, v235, v235 row_ror:8 row_mask:0xf bank_mask:0xc
    v_add_f32_dpp v243, v237, v237 row_ror:8 row_mask:0xf bank_mask:0xc
    v_mul_f32_e64 v179, v179, v110
    v_mfma_f32_32x32x16_bf16 v[194:209], a[28:31], a[172:175], v[194:209]
    v_add_f32_dpp v244, v242, v242 row_half_mirror row_mask:0xf bank_mask:0x5
    v_mul_f32 v180, v180, v110
    v_mul_f32 v181, v181, v110
    v_add_f32_dpp v244, v243, v243 row_half_mirror row_mask:0xf bank_mask:0xa
    v_mul_f32 v182, v182, v110
    v_mul_f32 v183, v183, v110
    v_mfma_f32_32x32x16_bf16 v[194:209], a[32:35], a[176:179], v[194:209]
    v_add_f32_dpp v242, v244, v244 quad_perm:[1,0,3,2] row_mask:0xf bank_mask:0xf
    v_mul_f32 v184, v184, v110
    v_mul_f32 v185, v185, v110
    v_add_f32_dpp v244, v242, v242 quad_perm:[2,3,0,1] row_mask:0xf bank_mask:0xf
    v_add_f32 v244, 0x3a7ba882, v244
    v_mul_f32 v186, v186, v110
    s_waitcnt lgkmcnt(0)
    v_mfma_f32_32x32x16_bf16 v[194:209], a[36:39], a[180:183], v[194:209]
    v_rsq_f32 v244, v244
    v_mul_f32 v187, v187, v110
    v_mul_f32 v244, 0x411cc471, v244
    v_mul_f32 v188, v188, v110
    v_mul_f32 v189, v189, v110
    v_mfma_f32_32x32x16_bf16 v[194:209], a[40:43], a[184:187], v[194:209]
    v_mov_b32_dpp v234, v244 row_newbcast:0 row_mask:0xf bank_mask:0xf
    v_mov_b32_dpp v235, v244 row_newbcast:8 row_mask:0xf bank_mask:0xf
    v_mov_b32_dpp v236, v244 row_newbcast:4 row_mask:0xf bank_mask:0xf
    v_mov_b32_dpp v237, v244 row_newbcast:12 row_mask:0xf bank_mask:0xf
    v_cvt_pk_bf16_f32 v72, v178, v179
    v_cvt_pk_bf16_f32 v73, v180, v181
    v_cvt_pk_bf16_f32 v74, v182, v183
    v_cvt_pk_bf16_f32 v75, v184, v185
    v_cvt_pk_bf16_f32 v76, v186, v187
    v_cvt_pk_bf16_f32 v77, v188, v189
    v_pk_mul_f32 v[210:211], v[210:211], v[234:235]
    v_pk_mul_f32 v[214:215], v[214:215], v[234:235]
    v_pk_mul_f32 v[218:219], v[218:219], v[234:235]
    v_pk_mul_f32 v[222:223], v[222:223], v[234:235]
    v_pk_mul_f32 v[226:227], v[226:227], v[234:235]
    v_pk_mul_f32 v[230:231], v[230:231], v[234:235]
    v_pk_mul_f32 v[212:213], v[212:213], v[236:237]
    v_pk_mul_f32 v[216:217], v[216:217], v[236:237]
    v_pk_mul_f32 v[220:221], v[220:221], v[236:237]
    v_pk_mul_f32 v[224:225], v[224:225], v[236:237]
    v_pk_mul_f32 v[228:229], v[228:229], v[236:237]
    v_pk_mul_f32 v[232:233], v[232:233], v[236:237]
    v_mfma_f32_32x32x16_bf16 v[194:209], a[44:47], a[188:191], v[194:209]
    v_cvt_pk_bf16_f32 v242, v210, v214
    v_cvt_pk_bf16_f32 v243, v218, v222
    v_cvt_pk_bf16_f32 v244, v226, v230
    v_cvt_pk_bf16_f32 v246, v211, v215
    v_cvt_pk_bf16_f32 v247, v219, v223
    v_cvt_pk_bf16_f32 v248, v227, v231
    v_mfma_f32_32x32x16_bf16 v[122:137], v[104:107], v[142:145], v[122:137]
    v_exp_f32 v159, v159
    v_exp_f32 v160, v160
    v_exp_f32_e64 v161, v161
    v_mfma_f32_32x32x16_bf16 v[178:193], a[0:3], a[168:171], 0
    v_exp_f32 v162, v162
    v_exp_f32 v163, v163
    v_exp_f32_e64 v164, v164
    v_mfma_f32_32x32x16_bf16 v[178:193], a[4:7], a[172:175], v[178:193]
    v_exp_f32 v165, v165
    v_exp_f32 v166, v166
    v_exp_f32_e64 v167, v167
    v_mfma_f32_32x32x8_bf16 v[122:137], v[108:109], v[70:71], v[122:137]
    v_exp_f32 v168, v168
    v_exp_f32 v169, v169
    v_cvt_pk_bf16_f32 v149, v152, v153
    v_cvt_pk_bf16_f32 v150, v154, v155
    v_mfma_f32_32x32x16_bf16 v[178:193], a[8:11], a[176:179], v[178:193]
    v_cvt_pk_bf16_f32 v151, v156, v157
    v_cvt_pk_bf16_f32 v152, v158, v159
    v_cvt_pk_bf16_f32 v153, v160, v161
    v_cvt_pk_bf16_f32 v174, v162, v163
    v_cvt_pk_bf16_f32 v175, v164, v165
    v_cvt_pk_bf16_f32 v176, v166, v167
    v_mfma_f32_32x32x16_bf16 v[178:193], a[12:15], a[180:183], v[178:193]
    v_rcp_f32_e64 v112, v134
    buffer_store_dwordx3 v[242:244], v60, s[8:11], s43 offen sc1
    v_pk_mul_f32 v[122:123], v[122:123], v[112:113] op_sel_hi:[1,0]
    v_pk_mul_f32 v[124:125], v[124:125], v[112:113] op_sel_hi:[1,0]
    v_pk_mul_f32 v[126:127], v[126:127], v[112:113] op_sel_hi:[1,0]
    v_pk_mul_f32 v[128:129], v[128:129], v[112:113] op_sel_hi:[1,0]
    v_pk_mul_f32 v[130:131], v[130:131], v[112:113] op_sel_hi:[1,0]
    v_pk_mul_f32 v[132:133], v[132:133], v[112:113] op_sel_hi:[1,0]
    v_mfma_f32_32x32x16_bf16 v[178:193], a[16:19], a[184:187], v[178:193]
    v_cvt_pk_bf16_f32 v242, v212, v216
    v_cvt_pk_bf16_f32 v243, v220, v224
    v_cvt_pk_bf16_f32 v244, v228, v232
    v_cvt_pk_bf16_f32 v114, v122, v123
    v_cvt_pk_bf16_f32 v115, v124, v125
    v_cvt_pk_bf16_f32 v116, v126, v127
    v_mfma_f32_32x32x16_bf16 v[178:193], a[20:23], a[188:191], v[178:193]
    buffer_store_dwordx3 v[246:248], v61, s[8:11], s43 offen sc1
    v_cvt_pk_bf16_f32 v117, v128, v129
    v_cvt_pk_bf16_f32 v118, v130, v131
    v_cvt_pk_bf16_f32 v246, v213, v217
    v_cvt_pk_bf16_f32 v247, v221, v225
    v_mfma_f32_32x32x8_bf16 v[210:225], v[64:65], v[66:67], 0
    v_cvt_pk_bf16_f32 v119, v132, v133
    v_cvt_pk_bf16_f32 v248, v229, v233
    v_cvt_pk_bf16_f32 v177, v168, v169
    v_exp_f32_e64 v170, v170
    v_fma_f32 v253, v194, v194, s48
    v_mfma_f32_32x32x16_bf16 v[210:225], a[144:147], a[48:51], v[210:225]
    v_cvt_pk_bf16_f32 v250, v170, 0
    v_fma_f32 v252, v178, v178, s48
    v_fmac_f32 v252, v179, v179
    v_fmac_f32 v252, v180, v180
    v_fmac_f32 v252, v181, v181
    v_fmac_f32 v252, v182, v182
    v_mfma_f32_32x32x16_bf16 v[210:225], a[148:151], a[52:55], v[210:225]
    v_fmac_f32 v252, v183, v183
    v_fmac_f32 v252, v184, v184
    v_fmac_f32 v252, v185, v185
    v_fmac_f32 v252, v186, v186
    v_fmac_f32 v252, v187, v187
    v_fmac_f32 v252, v188, v188
    v_mfma_f32_32x32x16_bf16 v[154:169], v[96:99], v[146:149], 0
    v_fmac_f32 v252, v189, v189
    v_fmac_f32 v253, v195, v195
    v_fmac_f32 v253, v196, v196
    v_fmac_f32 v253, v197, v197
    v_fmac_f32 v253, v198, v198
    v_fmac_f32 v253, v199, v199
    v_mfma_f32_32x32x16_bf16 v[210:225], a[152:155], a[56:59], v[210:225]
    v_fmac_f32 v253, v200, v200
    v_fmac_f32 v253, v201, v201
    v_fmac_f32 v253, v202, v202
    v_fmac_f32 v253, v203, v203
    v_fmac_f32 v253, v204, v204
    v_fmac_f32 v253, v205, v205
    v_mfma_f32_32x32x16_bf16 v[154:169], v[100:103], v[150:153], v[154:169]
    s_sub_u32 s46, s46, s44
    v_permlane32_swap_b32 v252, v253
    v_add_f32 v252, v252, v253
    v_rsq_f32 v252, v252
    v_mfma_f32_32x32x16_bf16 v[210:225], a[156:159], a[60:63], v[210:225]
    v_mul_f32 v252, v252, v68
    v_mov_b32 v253, v252
    v_add_u32 v52, s44, v52
    v_add_u32_e64 v53, s44, v53
    v_permlane32_swap_b32 v252, v253
    v_mfma_f32_32x32x16_bf16 v[154:169], v[104:107], v[174:177], v[154:169]
    v_mul_f32 v178, v178, v252
    v_mul_f32 v179, v179, v252
    v_mul_f32 v180, v180, v252
    v_mul_f32 v181, v181, v252
    v_mul_f32 v182, v182, v252
    v_mul_f32 v183, v183, v252
    v_mfma_f32_32x32x16_bf16 v[210:225], a[160:163], a[64:67], v[210:225]
    v_mul_f32 v184, v184, v252
    v_mul_f32 v185, v185, v252
    v_mul_f32 v186, v186, v252
    v_mul_f32 v187, v187, v252
    v_mul_f32 v188, v188, v252
    v_mul_f32 v189, v189, v252
    v_mfma_f32_32x32x8_bf16 v[154:169], v[108:109], v[250:251], v[154:169]
    v_cvt_pk_bf16_f32 v78, v178, v179
    v_cvt_pk_bf16_f32 v79, v180, v181
    v_cvt_pk_bf16_f32 v80, v182, v183
    v_cvt_pk_bf16_f32 v81, v184, v185
    v_cvt_pk_bf16_f32 v82, v186, v187
    v_cvt_pk_bf16_f32 v83, v188, v189
    v_mfma_f32_32x32x8_bf16 v[178:193], v[64:65], v[66:67], 0
    v_mul_f32 v194, v194, v253
    v_mul_f32 v195, v195, v253
    v_cvt_pk_bf16_f32 v90, v194, v195
    v_mul_f32 v196, v196, v253
    v_mul_f32 v197, v197, v253
    v_cvt_pk_bf16_f32 v91, v196, v197
    v_mfma_f32_32x32x16_bf16 v[178:193], a[168:171], a[48:51], v[178:193]
    v_mul_f32 v198, v198, v253
    v_mul_f32 v199, v199, v253
    v_cvt_pk_bf16_f32 v92, v198, v199
    v_mul_f32 v200, v200, v253
    v_mul_f32 v201, v201, v253
    v_cvt_pk_bf16_f32 v93, v200, v201
    v_mfma_f32_32x32x16_bf16 v[178:193], a[172:175], a[52:55], v[178:193]
    v_mul_f32 v202, v202, v253
    v_mul_f32 v203, v203, v253
    v_cvt_pk_bf16_f32 v94, v202, v203
    v_mul_f32 v204, v204, v253
    v_mul_f32 v205, v205, v253
    v_cvt_pk_bf16_f32 v95, v204, v205
    v_mfma_f32_32x32x16_bf16 v[178:193], a[176:179], a[56:59], v[178:193]
    v_rcp_f32_e64 v113, v166
    buffer_store_dwordx3 v[242:244], v62, s[8:11], s43 offen sc1
    v_pk_mul_f32 v[154:155], v[154:155], v[112:113] op_sel:[0,1] op_sel_hi:[1,1]
    v_pk_mul_f32 v[156:157], v[156:157], v[112:113] op_sel:[0,1] op_sel_hi:[1,1]
    v_pk_mul_f32 v[158:159], v[158:159], v[112:113] op_sel:[0,1] op_sel_hi:[1,1]
    v_pk_mul_f32 v[160:161], v[160:161], v[112:113] op_sel:[0,1] op_sel_hi:[1,1]
    v_pk_mul_f32 v[162:163], v[162:163], v[112:113] op_sel:[0,1] op_sel_hi:[1,1]
    v_pk_mul_f32 v[164:165], v[164:165], v[112:113] op_sel:[0,1] op_sel_hi:[1,1]
    v_mfma_f32_32x32x16_bf16 v[178:193], a[180:183], a[60:63], v[178:193]
    v_cvt_pk_bf16_f32 v146, v154, v155
    v_cvt_pk_bf16_f32 v147, v156, v157
    v_cvt_pk_bf16_f32 v148, v158, v159
    v_cvt_pk_bf16_f32 v149, v160, v161
    v_cvt_pk_bf16_f32 v150, v162, v163
    v_cvt_pk_bf16_f32 v151, v164, v165
    v_mfma_f32_32x32x16_bf16 v[178:193], a[184:187], a[64:67], v[178:193]
    s_sub_u32 s44, 0, s44
    ds_write_b64 v54, v[114:115] offset:0
    ds_write_b64 v54, v[116:117] offset:16
    ds_write_b64 v54, v[118:119] offset:32
    v_mfma_f32_32x32x16_bf16 v[210:225], a[164:167], a[68:71], v[210:225]
    v_add_u32 v54, s47, v54
    buffer_store_dwordx3 v[246:248], v63, s[8:11], s43 offen sc1
    v_mfma_f32_32x32x16_bf16 v[178:193], a[188:191], a[68:71], v[178:193]
    ds_write_b64 v55, v[146:147] offset:0
    ds_write_b64 v55, v[148:149] offset:16
    ds_write_b64 v55, v[150:151] offset:32
    v_readlane_b32 s43, v69, s36
    v_add_u32_e64 v55, s47, v55
    s_sub_u32 s47, 0, s47
    s_nop 2
    v_cvt_pk_bf16_f32 v96, v210, v211
    v_cvt_pk_bf16_f32 v97, v212, v213
    v_cvt_pk_bf16_f32 v98, v214, v215
    v_cvt_pk_bf16_f32 v99, v216, v217
    v_cvt_pk_bf16_f32 v100, v218, v219
    v_cvt_pk_bf16_f32 v101, v220, v221
    v_cvt_pk_bf16_f32 v104, v178, v179
    v_cvt_pk_bf16_f32 v105, v180, v181
    v_cvt_pk_bf16_f32 v106, v182, v183
    v_cvt_pk_bf16_f32 v107, v184, v185
    v_cvt_pk_bf16_f32 v108, v186, v187
    v_cvt_pk_bf16_f32 v109, v188, v189
    v_cvt_pk_bf16_f32 v102, v222, v223
    v_cvt_pk_bf16_f32 v103, v224, v225
    s_waitcnt vmcnt(4) lgkmcnt(0)
    s_barrier
    s_add_u32 s53, s33, 1
    s_cmp_lt_u32 s53, s34
    s_cbranch_scc1 F_LOOP
F_DRAIN:
    v_mfma_f32_32x32x8_bf16 v[146:161], a[204:205], a[210:211], v[26:41]
    s_add_u32 s33, s33, 1
    s_sub_u32 s44, 0, s44
    s_add_u32 s35, s35, 1
    v_readlane_b32 s42, v69, s35
    s_add_u32 s36, s36, 1
    s_and_b32 s36, s36, 63
    v_mfma_f32_32x32x16_bf16 v[146:161], v[84:87], v[78:81], v[146:161]
    v_mfma_f32_32x32x8_bf16 v[162:177], a[206:207], a[210:211], v[42:57]
    v_mfma_f32_32x32x8_bf16 v[146:161], v[88:89], v[82:83], v[146:161]
    v_mfma_f32_32x32x16_bf16 v[162:177], v[90:93], v[78:81], v[162:177]
    s_nop 4
    v_add_u32 v56, s47, v56
    v_mfma_f32_32x32x8_bf16 v[162:177], v[94:95], v[82:83], v[162:177]
    ds_read_b128 a[192:195], v56 offset:0
    ds_read_b128 a[196:199], v56 offset:64
    ds_read_b128 a[200:203], v56 offset:128
    v_mfma_f32_32x32x8_bf16 v[114:129], a[204:205], a[208:209], v[0:15]
    v_exp_f32 v146, v146
    v_mfma_f32_32x32x16_bf16 v[114:129], v[84:87], v[72:75], v[114:129]
    v_exp_f32 v147, v147
    v_mfma_f32_32x32x8_bf16 v[114:129], v[88:89], v[76:77], v[114:129]
    v_cvt_pk_bf16_f32 v146, v146, v147
    v_exp_f32 v148, v148
    v_exp_f32 v149, v149
    v_exp_f32 v150, v150
    v_mfma_f32_32x32x8_bf16 v[130:145], a[206:207], a[208:209], v[16:31]
    v_exp_f32 v151, v151
    v_exp_f32 v152, v152
    v_exp_f32 v153, v153
    v_mfma_f32_32x32x16_bf16 v[130:145], v[90:93], v[72:75], v[130:145]
    v_cvt_pk_bf16_f32 v147, v148, v149
    v_exp_f32 v154, v154
    v_exp_f32 v155, v155
    v_cvt_pk_bf16_f32 v148, v150, v151
    v_mfma_f32_32x32x8_bf16 v[130:145], v[94:95], v[76:77], v[130:145]
    v_exp_f32 v156, v156
    v_exp_f32 v157, v157
    v_exp_f32 v158, v158
    v_exp_f32 v159, v159
    v_exp_f32 v160, v160
    v_exp_f32 v161, v161
    v_exp_f32 v162, v162
    v_exp_f32 v163, v163
    v_exp_f32 v164, v164
    v_exp_f32 v165, v165
    v_exp_f32 v166, v166
    s_waitcnt lgkmcnt(0)
    v_mfma_f32_16x16x32_bf16 v[210:213], a[192:195], a[72:75], 0
    v_exp_f32 v167, v167
    v_mfma_f32_16x16x32_bf16 v[210:213], a[196:199], a[96:99], v[210:213]
    v_exp_f32 v168, v168
    v_mfma_f32_16x16x32_bf16 v[210:213], a[200:203], a[120:123], v[210:213]
    v_exp_f32 v169, v169
    v_mfma_f32_16x16x32_bf16 v[214:217], a[192:195], a[76:79], 0
    v_cvt_pk_bf16_f32 v149, v152, v153
    v_cvt_pk_bf16_f32 v150, v154, v155
    v_mfma_f32_16x16x32_bf16 v[214:217], a[196:199], a[100:103], v[214:217]
    v_cvt_pk_bf16_f32 v151, v156, v157
    v_cvt_pk_bf16_f32 v152, v158, v159
    v_mfma_f32_16x16x32_bf16 v[214:217], a[200:203], a[124:127], v[214:217]
    v_cvt_pk_bf16_f32 v153, v160, v161
    v_cvt_pk_bf16_f32 v174, v162, v163
    v_mfma_f32_16x16x32_bf16 v[218:221], a[192:195], a[80:83], 0
    v_cvt_pk_bf16_f32 v175, v164, v165
    v_cvt_pk_bf16_f32 v176, v166, v167
    v_mfma_f32_16x16x32_bf16 v[218:221], a[196:199], a[104:107], v[218:221]
    v_cvt_pk_bf16_f32 v177, v168, v169
    v_exp_f32 v170, v170
    v_mfma_f32_32x32x16_bf16 v[154:169], v[96:99], v[146:149], 0
    v_cvt_pk_bf16_f32 v250, v170, 0
    v_exp_f32 v122, v122
    v_exp_f32 v123, v123
    v_exp_f32 v124, v124
    v_mfma_f32_32x32x16_bf16 v[154:169], v[100:103], v[150:153], v[154:169]
    v_exp_f32 v125, v125
    v_exp_f32 v126, v126
    v_exp_f32 v127, v127
    v_mfma_f32_32x32x16_bf16 v[154:169], v[104:107], v[174:177], v[154:169]
    v_exp_f32 v128, v128
    v_exp_f32 v129, v129
    v_exp_f32 v130, v130
    v_mfma_f32_32x32x8_bf16 v[154:169], v[108:109], v[250:251], v[154:169]
    v_exp_f32 v131, v131
    v_exp_f32 v132, v132
    v_exp_f32 v133, v133
    v_mfma_f32_16x16x32_bf16 v[218:221], a[200:203], a[128:131], v[218:221]
    v_exp_f32 v134, v134
    v_mfma_f32_16x16x32_bf16 v[222:225], a[192:195], a[84:87], 0
    v_exp_f32 v135, v135
    v_mfma_f32_16x16x32_bf16 v[222:225], a[196:199], a[108:111], v[222:225]
    v_exp_f32 v136, v136
    v_mfma_f32_16x16x32_bf16 v[222:225], a[200:203], a[132:135], v[222:225]
    v_exp_f32 v137, v137
    v_mfma_f32_16x16x32_bf16 v[226:229], a[192:195], a[88:91], 0
    v_cvt_pk_bf16_f32 v142, v130, v131
    v_cvt_pk_bf16_f32 v143, v132, v133
    v_mfma_f32_16x16x32_bf16 v[226:229], a[196:199], a[112:115], v[226:229]
    v_cvt_pk_bf16_f32 v144, v134, v135
    v_cvt_pk_bf16_f32 v145, v136, v137
    v_mfma_f32_16x16x32_bf16 v[226:229], a[200:203], a[136:139], v[226:229]
    v_exp_f32 v114, v114
    v_mfma_f32_16x16x32_bf16 v[230:233], a[192:195], a[92:95], 0
    v_exp_f32 v115, v115
    v_mfma_f32_16x16x32_bf16 v[230:233], a[196:199], a[116:119], v[230:233]
    v_cvt_pk_bf16_f32 v114, v114, v115
    v_exp_f32 v116, v116
    v_mfma_f32_16x16x32_bf16 v[230:233], a[200:203], a[140:143], v[230:233]
    v_exp_f32 v117, v117
    v_exp_f32 v118, v118
    v_cvt_pk_bf16_f32 v115, v116, v117
    v_exp_f32 v119, v119
    v_exp_f32 v120, v120
    v_cvt_pk_bf16_f32 v116, v118, v119
    v_cvt_pk_bf16_f32 v118, v122, v123
    v_cvt_pk_bf16_f32 v119, v124, v125
    v_pk_mul_f32 v[234:235], v[210:211], v[210:211]
    v_pk_mul_f32 v[236:237], v[212:213], v[212:213]
    v_pk_fma_f32 v[234:235], v[214:215], v[214:215], v[234:235]
    v_pk_fma_f32 v[236:237], v[216:217], v[216:217], v[236:237]
    v_pk_fma_f32 v[234:235], v[218:219], v[218:219], v[234:235]
    v_pk_fma_f32 v[236:237], v[220:221], v[220:221], v[236:237]
    v_pk_fma_f32 v[234:235], v[222:223], v[222:223], v[234:235]
    v_pk_fma_f32 v[236:237], v[224:225], v[224:225], v[236:237]
    v_pk_fma_f32 v[234:235], v[226:227], v[226:227], v[234:235]
    v_pk_fma_f32 v[236:237], v[228:229], v[228:229], v[236:237]
    v_pk_fma_f32 v[234:235], v[230:231], v[230:231], v[234:235]
    v_pk_fma_f32 v[236:237], v[232:233], v[232:233], v[236:237]
    v_exp_f32 v121, v121
    v_exp_f32 v138, v138
    v_cvt_pk_bf16_f32 v117, v120, v121
    v_cvt_pk_bf16_f32 v120, v126, v127
    v_cvt_pk_bf16_f32 v121, v128, v129
    v_mfma_f32_32x32x16_bf16 v[122:137], v[96:99], v[114:117], 0
    v_cvt_pk_bf16_f32 v70, v138, 0
    v_add_f32_dpp v242, v234, v234 row_ror:8 row_mask:0xf bank_mask:0x3
    v_add_f32_dpp v243, v236, v236 row_ror:8 row_mask:0xf bank_mask:0x3
    v_rcp_f32 v113, v166
    v_add_f32_dpp v242, v235, v235 row_ror:8 row_mask:0xf bank_mask:0xc
    v_add_f32_dpp v243, v237, v237 row_ror:8 row_mask:0xf bank_mask:0xc
    s_nop 0
    v_add_f32_dpp v244, v242, v242 row_half_mirror row_mask:0xf bank_mask:0x5
    v_pk_mul_f32 v[154:155], v[154:155], v[112:113] op_sel:[0,1] op_sel_hi:[1,1]
    v_pk_mul_f32 v[156:157], v[156:157], v[112:113] op_sel:[0,1] op_sel_hi:[1,1]
    v_pk_mul_f32 v[158:159], v[158:159], v[112:113] op_sel:[0,1] op_sel_hi:[1,1]
    v_pk_mul_f32 v[160:161], v[160:161], v[112:113] op_sel:[0,1] op_sel_hi:[1,1]
    v_pk_mul_f32 v[162:163], v[162:163], v[112:113] op_sel:[0,1] op_sel_hi:[1,1]
    v_pk_mul_f32 v[164:165], v[164:165], v[112:113] op_sel:[0,1] op_sel_hi:[1,1]
    v_mfma_f32_32x32x16_bf16 v[122:137], v[100:103], v[118:121], v[122:137]
    v_add_f32_dpp v244, v243, v243 row_half_mirror row_mask:0xf bank_mask:0xa
    v_cvt_pk_bf16_f32 v146, v154, v155
    v_cvt_pk_bf16_f32 v147, v156, v157
    v_add_f32_dpp v242, v244, v244 quad_perm:[1,0,3,2] row_mask:0xf bank_mask:0xf
    v_cvt_pk_bf16_f32 v148, v158, v159
    v_cvt_pk_bf16_f32 v149, v160, v161
    v_mfma_f32_32x32x16_bf16 v[122:137], v[104:107], v[142:145], v[122:137]
    v_add_f32_dpp v244, v242, v242 quad_perm:[2,3,0,1] row_mask:0xf bank_mask:0xf
    v_add_f32 v244, 0x3a7ba882, v244
    v_rsq_f32 v244, v244
    v_cvt_pk_bf16_f32 v150, v162, v163
    v_mul_f32 v244, 0x411cc471, v244
    v_mfma_f32_32x32x8_bf16 v[122:137], v[108:109], v[70:71], v[122:137]
    v_cvt_pk_bf16_f32 v151, v164, v165
    v_mov_b32_dpp v234, v244 row_newbcast:0 row_mask:0xf bank_mask:0xf
    v_mov_b32_dpp v235, v244 row_newbcast:8 row_mask:0xf bank_mask:0xf
    v_mov_b32_dpp v236, v244 row_newbcast:4 row_mask:0xf bank_mask:0xf
    v_mov_b32_dpp v237, v244 row_newbcast:12 row_mask:0xf bank_mask:0xf
    ds_write_b64 v55, v[146:147] offset:0
    ds_write_b64 v55, v[148:149] offset:16
    ds_write_b64 v55, v[150:151] offset:32
    v_pk_mul_f32 v[210:211], v[210:211], v[234:235]
    v_pk_mul_f32 v[214:215], v[214:215], v[234:235]
    v_pk_mul_f32 v[218:219], v[218:219], v[234:235]
    v_pk_mul_f32 v[222:223], v[222:223], v[234:235]
    v_pk_mul_f32 v[226:227], v[226:227], v[234:235]
    v_pk_mul_f32 v[230:231], v[230:231], v[234:235]
    v_pk_mul_f32 v[212:213], v[212:213], v[236:237]
    v_pk_mul_f32 v[216:217], v[216:217], v[236:237]
    v_pk_mul_f32 v[220:221], v[220:221], v[236:237]
    v_pk_mul_f32 v[224:225], v[224:225], v[236:237]
    v_pk_mul_f32 v[228:229], v[228:229], v[236:237]
    v_pk_mul_f32 v[232:233], v[232:233], v[236:237]
    v_cvt_pk_bf16_f32 v242, v210, v214
    v_cvt_pk_bf16_f32 v243, v218, v222
    v_cvt_pk_bf16_f32 v244, v226, v230
    buffer_store_dwordx3 v[242:244], v60, s[8:11], s43 offen sc1
    v_cvt_pk_bf16_f32 v246, v211, v215
    v_cvt_pk_bf16_f32 v247, v219, v223
    v_cvt_pk_bf16_f32 v248, v227, v231
    buffer_store_dwordx3 v[246:248], v61, s[8:11], s43 offen sc1
    v_cvt_pk_bf16_f32 v242, v212, v216
    v_cvt_pk_bf16_f32 v243, v220, v224
    v_cvt_pk_bf16_f32 v244, v228, v232
    buffer_store_dwordx3 v[242:244], v62, s[8:11], s43 offen sc1
    v_cvt_pk_bf16_f32 v246, v213, v217
    v_cvt_pk_bf16_f32 v247, v221, v225
    v_cvt_pk_bf16_f32 v248, v229, v233
    buffer_store_dwordx3 v[246:248], v63, s[8:11], s43 offen sc1
    v_readlane_b32 s43, v69, s36
    v_rcp_f32 v112, v134
    v_add_u32 v55, s47, v55
    v_pk_mul_f32 v[122:123], v[122:123], v[112:113] op_sel_hi:[1,0]
    v_pk_mul_f32 v[124:125], v[124:125], v[112:113] op_sel_hi:[1,0]
    v_pk_mul_f32 v[126:127], v[126:127], v[112:113] op_sel_hi:[1,0]
    v_pk_mul_f32 v[128:129], v[128:129], v[112:113] op_sel_hi:[1,0]
    v_pk_mul_f32 v[130:131], v[130:131], v[112:113] op_sel_hi:[1,0]
    v_pk_mul_f32 v[132:133], v[132:133], v[112:113] op_sel_hi:[1,0]
    v_cvt_pk_bf16_f32 v114, v122, v123
    v_cvt_pk_bf16_f32 v115, v124, v125
    v_cvt_pk_bf16_f32 v116, v126, v127
    v_cvt_pk_bf16_f32 v117, v128, v129
    v_cvt_pk_bf16_f32 v118, v130, v131
    v_cvt_pk_bf16_f32 v119, v132, v133
    ds_write_b64 v54, v[114:115] offset:0
    ds_write_b64 v54, v[116:117] offset:16
    ds_write_b64 v54, v[118:119] offset:32
    v_add_u32 v54, s47, v54
    s_sub_u32 s47, 0, s47
    s_waitcnt vmcnt(4) lgkmcnt(0)
    s_barrier
    s_branch L_TAIL
S_IT0:
.p2align 3
S_LOOP:
    s_cmp_eq_u32 s33, s37
    s_cbranch_scc1 S1_SWAP
S1_SWAP_RET:
    v_mfma_f32_32x32x16_bf16 v[114:129], v[84:87], v[72:75], v[0:15]
    ds_read_b128 a[144:147], v52 offset:0
    ds_read_b128 a[148:151], v52 offset:32
    ds_read_b128 a[152:155], v52 offset:64
    ds_read_b128 a[156:159], v52 offset:96
    ds_read_b128 a[160:163], v52 offset:128
    ds_read_b128 a[164:167], v52 offset:160
    v_mfma_f32_32x32x8_bf16 v[114:129], v[88:89], v[76:77], v[114:129]
    ds_read_b128 a[168:171], v53 offset:0
    ds_read_b128 a[172:175], v53 offset:32
    ds_read_b128 a[176:179], v53 offset:64
    ds_read_b128 a[180:183], v53 offset:96
    ds_read_b128 a[184:187], v53 offset:128
    ds_read_b128 a[188:191], v53 offset:160
    v_mfma_f32_32x32x16_bf16 v[130:145], v[90:93], v[72:75], v[16:31]
    s_mov_b32 m0, s46
    s_add_u32 s33, s33, 1
    s_add_u32 s35, s35, 1
    s_add_u32 s36, s36, 1
    s_and_b32 s36, s36, 63
    v_max3_f32 v112, v114, v115, v116
    v_mfma_f32_32x32x8_bf16 v[130:145], v[94:95], v[76:77], v[130:145]
    buffer_load_dwordx4 v57, s[4:7], s42 offen nt lds
    s_add_u32 m0, s46, 4096
    v_max3_f32 v112, v112, v117, v118
    v_mfma_f32_32x32x16_bf16 v[162:177], v[90:93], v[78:81], v[42:57]
    buffer_load_dwordx4 v58, s[4:7], s42 offen nt lds
    s_add_u32 m0, s46, 8192
    v_max3_f32 v112, v112, v119, v120
    v_mfma_f32_32x32x16_bf16 v[146:161], v[84:87], v[78:81], v[26:41]
    buffer_load_dwordx4 v59, s[4:7], s42 offen nt lds
    v_max3_f32 v112, v112, v121, v122
    v_max3_f32 v112, v112, v123, v124
    v_mfma_f32_32x32x8_bf16 v[146:161], v[88:89], v[82:83], v[146:161]
    v_add_u32 v56, s47, v56
    v_max3_f32 v112, v112, v125, v126
    v_max3_f32 v112, v112, v127, v128
    v_max3_f32 v112, v112, v129, v130
    v_max3_f32 v112, v112, v131, v132
    v_max3_f32 v112, v112, v133, v134
    v_mfma_f32_32x32x8_bf16 v[162:177], v[94:95], v[82:83], v[162:177]
    ds_read_b128 a[192:195], v56 offset:0
    ds_read_b128 a[196:199], v56 offset:64
    ds_read_b128 a[200:203], v56 offset:128
    v_max3_f32 v112, v112, v135, v136
    s_waitcnt lgkmcnt(9)
    v_mfma_f32_32x32x16_bf16 v[178:193], a[0:3], a[144:147], 0
    v_max3_f32 v113, v146, v147, v148
    v_max3_f32 v113, v113, v149, v150
    v_max3_f32 v113, v113, v151, v152
    v_max3_f32 v113, v113, v153, v154
    v_max3_f32 v113, v113, v155, v156
    v_max3_f32 v113, v113, v157, v158
    v_mfma_f32_32x32x16_bf16 v[178:193], a[4:7], a[148:151], v[178:193]
    v_max3_f32 v113, v113, v159, v160
    v_max3_f32 v113, v113, v161, v162
    v_max3_f32 v113, v113, v163, v164
    v_max3_f32 v113, v113, v165, v166
    v_max3_f32 v113, v113, v167, v168
    v_max3_f32 v113, v113, v169, v170
    v_mfma_f32_32x32x16_bf16 v[178:193], a[8:11], a[152:155], v[178:193]
    v_mov_b32 v255, v113
    v_max3_f32 v112, v112, v137, v138
    v_mov_b32 v254, v112
    v_permlane32_swap_b32 v113, v255
    v_max_f32_e64 v113, v113, v255
    v_mfma_f32_32x32x16_bf16 v[178:193], a[12:15], a[156:159], v[178:193]
    v_sub_f32 v146, v146, v113
    v_sub_f32 v147, v147, v113
    v_sub_f32 v148, v148, v113
    v_sub_f32 v149, v149, v113
    v_sub_f32 v150, v150, v113
    v_sub_f32 v151, v151, v113
    v_mfma_f32_32x32x16_bf16 v[178:193], a[16:19], a[160:163], v[178:193]
    v_sub_f32 v152, v152, v113
    v_sub_f32 v153, v153, v113
    v_sub_f32 v154, v154, v113
    v_sub_f32 v155, v155, v113
    v_sub_f32 v156, v156, v113
    v_sub_f32 v157, v157, v113
    v_mfma_f32_32x32x16_bf16 v[178:193], a[20:23], a[164:167], v[178:193]
    v_sub_f32 v158, v158, v113
    v_sub_f32 v159, v159, v113
    v_sub_f32 v160, v160, v113
    v_sub_f32 v161, v161, v113
    v_sub_f32 v162, v162, v113
    v_sub_f32 v163, v163, v113
    v_mfma_f32_32x32x16_bf16 v[194:209], a[24:27], a[144:147], 0
    v_sub_f32 v164, v164, v113
    v_sub_f32 v165, v165, v113
    v_sub_f32 v166, v166, v113
    v_sub_f32 v167, v167, v113
    v_sub_f32_e64 v168, v168, v113
    v_fma_f32 v110, v178, v178, s48
    v_mfma_f32_32x32x16_bf16 v[194:209], a[28:31], a[148:151], v[194:209]
    v_fmac_f32 v110, v179, v179
    v_fmac_f32 v110, v180, v180
    v_fmac_f32 v110, v181, v181
    v_fmac_f32 v110, v182, v182
    v_fmac_f32 v110, v183, v183
    v_fmac_f32 v110, v184, v184
    v_mfma_f32_32x32x16_bf16 v[194:209], a[32:35], a[152:155], v[194:209]
    v_fmac_f32 v110, v185, v185
    v_fmac_f32 v110, v186, v186
    v_fmac_f32 v110, v187, v187
    v_fmac_f32 v110, v188, v188
    v_fmac_f32 v110, v189, v189
    v_sub_f32 v169, v169, v113
    v_mfma_f32_32x32x16_bf16 v[194:209], a[36:39], a[156:159], v[194:209]
    v_sub_f32 v170, v170, v113
    v_exp_f32 v146, v146
    v_exp_f32_e64 v147, v147
    v_readlane_b32 s42, v69, s35
    v_mfma_f32_32x32x16_bf16 v[194:209], a[40:43], a[160:163], v[194:209]
    v_exp_f32 v148, v148
    v_exp_f32 v149, v149
    v_exp_f32_e64 v150, v150
    v_mfma_f32_32x32x16_bf16 v[194:209], a[44:47], a[164:167], v[194:209]
    v_exp_f32 v151, v151
    v_exp_f32 v152, v152
    v_exp_f32 v153, v153
    s_waitcnt lgkmcnt(0)
    v_mfma_f32_16x16x32_bf16 v[210:213], a[192:195], a[72:75], 0
    v_exp_f32_e64 v154, v154
    v_mfma_f32_16x16x32_bf16 v[214:217], a[192:195], a[76:79], 0
    v_exp_f32_e64 v155, v155
    v_mfma_f32_16x16x32_bf16 v[218:221], a[192:195], a[80:83], 0
    v_exp_f32_e64 v156, v156
    v_mfma_f32_16x16x32_bf16 v[222:225], a[192:195], a[84:87], 0
    v_exp_f32_e64 v157, v157
    v_mfma_f32_16x16x32_bf16 v[226:229], a[192:195], a[88:91], 0
    v_fma_f32 v111, v194, v194, s48
    v_fmac_f32_e64 v111, v195, v195
    v_mfma_f32_16x16x32_bf16 v[230:233], a[192:195], a[92:95], 0
    v_fmac_f32 v111, v196, v196
    v_fmac_f32 v111, v197, v197
    v_mfma_f32_16x16x32_bf16 v[210:213], a[196:199], a[96:99], v[210:213]
    v_fmac_f32 v111, v198, v198
    v_fmac_f32 v111, v199, v199
    v_mfma_f32_16x16x32_bf16 v[214:217], a[196:199], a[100:103], v[214:217]
    v_fmac_f32 v111, v200, v200
    v_fmac_f32 v111, v201, v201
    v_mfma_f32_16x16x32_bf16 v[218:221], a[196:199], a[104:107], v[218:221]
    v_fmac_f32 v111, v202, v202
    v_fmac_f32 v111, v203, v203
    v_mfma_f32_16x16x32_bf16 v[222:225], a[196:199], a[108:111], v[222:225]
    v_fmac_f32 v111, v204, v204
    v_fmac_f32 v111, v205, v205
    v_mfma_f32_16x16x32_bf16 v[226:229], a[196:199], a[112:115], v[226:229]
    v_exp_f32_e64 v158, v158
    v_mfma_f32_16x16x32_bf16 v[230:233], a[196:199], a[116:119], v[230:233]
    v_permlane32_swap_b32 v110, v111
    v_mfma_f32_16x16x32_bf16 v[210:213], a[200:203], a[120:123], v[210:213]
    v_add_f32 v110, v110, v111
    v_cvt_pk_bf16_f32 v146, v146, v147
    v_mfma_f32_16x16x32_bf16 v[214:217], a[200:203], a[124:127], v[214:217]
    v_rsq_f32_e64 v110, v110
    v_mfma_f32_16x16x32_bf16 v[218:221], a[200:203], a[128:131], v[218:221]
    v_mul_f32 v110, v110, v68
    v_mov_b32 v111, v110
    v_mfma_f32_16x16x32_bf16 v[222:225], a[200:203], a[132:135], v[222:225]
    v_exp_f32_e64 v159, v159
    v_mfma_f32_16x16x32_bf16 v[226:229], a[200:203], a[136:139], v[226:229]
    v_permlane32_swap_b32 v110, v111
    v_mfma_f32_16x16x32_bf16 v[230:233], a[200:203], a[140:143], v[230:233]
    v_mul_f32 v178, v178, v110
    v_mul_f32 v179, v179, v110
    v_mul_f32 v180, v180, v110
    v_mul_f32 v181, v181, v110
    v_mul_f32 v182, v182, v110
    v_mul_f32 v183, v183, v110
    v_mul_f32 v184, v184, v110
    v_mul_f32_e64 v185, v185, v110
    v_pk_mul_f32 v[234:235], v[210:211], v[210:211]
    v_pk_mul_f32 v[236:237], v[212:213], v[212:213]
    v_pk_fma_f32 v[234:235], v[214:215], v[214:215], v[234:235]
    v_pk_fma_f32 v[236:237], v[216:217], v[216:217], v[236:237]
    v_pk_fma_f32 v[234:235], v[218:219], v[218:219], v[234:235]
    v_pk_fma_f32 v[236:237], v[220:221], v[220:221], v[236:237]
    v_pk_fma_f32 v[234:235], v[222:223], v[222:223], v[234:235]
    v_pk_fma_f32 v[236:237], v[224:225], v[224:225], v[236:237]
    v_pk_fma_f32 v[234:235], v[226:227], v[226:227], v[234:235]
    v_pk_fma_f32 v[236:237], v[228:229], v[228:229], v[236:237]
    v_pk_fma_f32 v[234:235], v[230:231], v[230:231], v[234:235]
    v_pk_fma_f32 v[236:237], v[232:233], v[232:233], v[236:237]
    v_mul_f32 v186, v186, v110
    v_mul_f32 v187, v187, v110
    v_mul_f32 v188, v188, v110
    v_mul_f32 v189, v189, v110
    v_cvt_pk_bf16_f32 v72, v178, v179
    v_cvt_pk_bf16_f32 v73, v180, v181
    v_cvt_pk_bf16_f32 v74, v182, v183
    v_cvt_pk_bf16_f32 v75, v184, v185
    v_cvt_pk_bf16_f32 v76, v186, v187
    v_cvt_pk_bf16_f32 v77, v188, v189
    v_mfma_f32_32x32x16_bf16 v[178:193], a[0:3], a[168:171], 0
    v_mul_f32 v194, v194, v111
    v_mul_f32 v195, v195, v111
    v_mul_f32 v196, v196, v111
    v_mul_f32 v197, v197, v111
    v_mul_f32 v198, v198, v111
    v_mul_f32 v199, v199, v111
    v_mfma_f32_32x32x16_bf16 v[178:193], a[4:7], a[172:175], v[178:193]
    v_mul_f32 v200, v200, v111
    v_mul_f32 v201, v201, v111
    v_mul_f32 v202, v202, v111
    v_mul_f32 v203, v203, v111
    v_mul_f32 v204, v204, v111
    v_mul_f32 v205, v205, v111
    v_mfma_f32_32x32x16_bf16 v[178:193], a[8:11], a[176:179], v[178:193]
    v_cvt_pk_bf16_f32 v84, v194, v195
    v_cvt_pk_bf16_f32 v85, v196, v197
    v_cvt_pk_bf16_f32 v86, v198, v199
    v_cvt_pk_bf16_f32 v87, v200, v201
    v_cvt_pk_bf16_f32 v88, v202, v203
    v_cvt_pk_bf16_f32 v89, v204, v205
    v_mfma_f32_32x32x16_bf16 v[178:193], a[12:15], a[180:183], v[178:193]
    v_add_f32_dpp v242, v234, v234 row_ror:8 row_mask:0xf bank_mask:0x3
    v_add_f32_dpp v243, v236, v236 row_ror:8 row_mask:0xf bank_mask:0x3
    v_exp_f32_e64 v160, v160
    v_add_f32_dpp v242, v235, v235 row_ror:8 row_mask:0xf bank_mask:0xc
    v_add_f32_dpp v243, v237, v237 row_ror:8 row_mask:0xf bank_mask:0xc
    v_mfma_f32_32x32x16_bf16 v[178:193], a[16:19], a[184:187], v[178:193]
    v_add_f32_dpp v244, v242, v242 row_half_mirror row_mask:0xf bank_mask:0x5
    v_exp_f32 v161, v161
    v_exp_f32 v162, v162
    v_add_f32_dpp v244, v243, v243 row_half_mirror row_mask:0xf bank_mask:0xa
    v_mfma_f32_32x32x16_bf16 v[194:209], a[24:27], a[168:171], 0
    v_exp_f32_e64 v163, v163
    v_add_f32_dpp v242, v244, v244 quad_perm:[1,0,3,2] row_mask:0xf bank_mask:0xf
    v_exp_f32_e64 v164, v164
    v_cvt_pk_bf16_f32 v147, v148, v149
    v_mfma_f32_32x32x16_bf16 v[194:209], a[28:31], a[172:175], v[194:209]
    v_add_f32_dpp v244, v242, v242 quad_perm:[2,3,0,1] row_mask:0xf bank_mask:0xf
    v_add_f32 v244, 0x3a7ba882, v244
    v_rsq_f32 v244, v244
    v_exp_f32 v165, v165
    v_mfma_f32_32x32x16_bf16 v[178:193], a[20:23], a[188:191], v[178:193]
    v_mul_f32 v244, 0x411cc471, v244
    v_exp_f32 v166, v166
    v_exp_f32 v167, v167
    v_mov_b32_dpp v234, v244 row_newbcast:0 row_mask:0xf bank_mask:0xf
    v_mfma_f32_32x32x16_bf16 v[194:209], a[32:35], a[176:179], v[194:209]
    v_mov_b32_dpp v235, v244 row_newbcast:8 row_mask:0xf bank_mask:0xf
    v_mov_b32_dpp v236, v244 row_newbcast:4 row_mask:0xf bank_mask:0xf
    v_mov_b32_dpp v237, v244 row_newbcast:12 row_mask:0xf bank_mask:0xf
    v_exp_f32 v168, v168
    v_exp_f32 v169, v169
    v_exp_f32_e64 v170, v170
    v_cvt_pk_bf16_f32 v148, v150, v151
    v_pk_mul_f32 v[210:211], v[210:211], v[234:235]
    v_pk_mul_f32 v[214:215], v[214:215], v[234:235]
    v_pk_mul_f32 v[218:219], v[218:219], v[234:235]
    v_pk_mul_f32 v[222:223], v[222:223], v[234:235]
    v_pk_mul_f32 v[226:227], v[226:227], v[234:235]
    v_pk_mul_f32 v[230:231], v[230:231], v[234:235]
    v_pk_mul_f32 v[212:213], v[212:213], v[236:237]
    v_pk_mul_f32 v[216:217], v[216:217], v[236:237]
    v_pk_mul_f32 v[220:221], v[220:221], v[236:237]
    v_pk_mul_f32 v[224:225], v[224:225], v[236:237]
    v_pk_mul_f32 v[228:229], v[228:229], v[236:237]
    v_pk_mul_f32 v[232:233], v[232:233], v[236:237]
    v_mfma_f32_32x32x16_bf16 v[194:209], a[36:39], a[180:183], v[194:209]
    v_fma_f32 v252, v178, v178, s48
    v_fmac_f32 v252, v179, v179
    v_fmac_f32 v252, v180, v180
    v_fmac_f32 v252, v181, v181
    v_fmac_f32 v252, v182, v182
    v_fmac_f32_e64 v252, v183, v183
    v_mfma_f32_32x32x16_bf16 v[194:209], a[40:43], a[184:187], v[194:209]
    v_fmac_f32 v252, v184, v184
    v_fmac_f32 v252, v185, v185
    v_fmac_f32 v252, v186, v186
    v_fmac_f32 v252, v187, v187
    v_fmac_f32 v252, v188, v188
    v_fmac_f32 v252, v189, v189
    v_mfma_f32_32x32x16_bf16 v[194:209], a[44:47], a[188:191], v[194:209]
    v_cvt_pk_bf16_f32 v242, v210, v214
    v_cvt_pk_bf16_f32 v243, v218, v222
    v_cvt_pk_bf16_f32 v246, v211, v215
    v_cvt_pk_bf16_f32 v247, v219, v223
    v_cvt_pk_bf16_f32 v244, v226, v230
    buffer_store_dwordx3 v[242:244], v60, s[8:11], s43 offen sc1
    v_cvt_pk_bf16_f32 v248, v227, v231
    buffer_store_dwordx3 v[246:248], v61, s[8:11], s43 offen sc1
    v_cvt_pk_bf16_f32 v242, v212, v216
    v_cvt_pk_bf16_f32 v243, v220, v224
    v_cvt_pk_bf16_f32 v246, v213, v217
    v_cvt_pk_bf16_f32 v247, v221, v225
    v_mfma_f32_32x32x8_bf16 v[210:225], v[64:65], v[66:67], 0
    v_fma_f32 v253, v194, v194, s48
    v_fmac_f32 v253, v195, v195
    v_fmac_f32 v253, v196, v196
    v_fmac_f32 v253, v197, v197
    v_fmac_f32 v253, v198, v198
    v_fmac_f32_e64 v253, v199, v199
    v_mfma_f32_32x32x16_bf16 v[210:225], a[144:147], a[48:51], v[210:225]
    v_fmac_f32 v253, v200, v200
    v_fmac_f32 v253, v201, v201
    v_fmac_f32 v253, v202, v202
    v_fmac_f32 v253, v203, v203
    v_fmac_f32 v253, v204, v204
    v_fmac_f32 v253, v205, v205
    v_mfma_f32_32x32x16_bf16 v[210:225], a[148:151], a[52:55], v[210:225]
    v_cvt_pk_bf16_f32 v149, v152, v153
    v_permlane32_swap_b32 v252, v253
    v_add_f32 v252, v252, v253
    v_rsq_f32_e64 v252, v252
    v_mfma_f32_32x32x16_bf16 v[210:225], a[152:155], a[56:59], v[210:225]
    v_mul_f32 v252, v252, v68
    v_mov_b32 v253, v252
    v_cvt_pk_bf16_f32 v150, v154, v155
    v_cvt_pk_bf16_f32 v151, v156, v157
    v_permlane32_swap_b32 v252, v253
    v_mfma_f32_32x32x16_bf16 v[210:225], a[156:159], a[60:63], v[210:225]
    v_mul_f32 v178, v178, v252
    v_mul_f32 v179, v179, v252
    v_mul_f32 v180, v180, v252
    v_mul_f32 v181, v181, v252
    v_mul_f32 v182, v182, v252
    v_mul_f32_e64 v183, v183, v252
    v_mfma_f32_32x32x16_bf16 v[210:225], a[160:163], a[64:67], v[210:225]
    v_mul_f32 v184, v184, v252
    v_mul_f32 v185, v185, v252
    v_mul_f32 v186, v186, v252
    v_mul_f32 v187, v187, v252
    v_mul_f32 v188, v188, v252
    v_mul_f32 v189, v189, v252
    v_mfma_f32_32x32x16_bf16 v[210:225], a[164:167], a[68:71], v[210:225]
    v_cvt_pk_bf16_f32 v78, v178, v179
    v_cvt_pk_bf16_f32 v79, v180, v181
    v_cvt_pk_bf16_f32 v80, v182, v183
    v_cvt_pk_bf16_f32 v81, v184, v185
    v_cvt_pk_bf16_f32 v82, v186, v187
    v_cvt_pk_bf16_f32 v83, v188, v189
    v_mfma_f32_32x32x8_bf16 v[178:193], v[64:65], v[66:67], 0
    v_mul_f32 v194, v194, v253
    v_mul_f32 v195, v195, v253
    v_mul_f32 v196, v196, v253
    v_mul_f32 v197, v197, v253
    v_mul_f32 v198, v198, v253
    v_mul_f32 v199, v199, v253
    v_mfma_f32_32x32x16_bf16 v[178:193], a[168:171], a[48:51], v[178:193]
    v_mul_f32 v200, v200, v253
    v_mul_f32 v201, v201, v253
    v_mul_f32 v202, v202, v253
    v_mul_f32 v203, v203, v253
    v_mul_f32 v204, v204, v253
    v_mul_f32 v205, v205, v253
    v_mfma_f32_32x32x16_bf16 v[178:193], a[172:175], a[52:55], v[178:193]
    v_cvt_pk_bf16_f32 v90, v194, v195
    v_cvt_pk_bf16_f32 v91, v196, v197
    v_cvt_pk_bf16_f32 v92, v198, v199
    v_cvt_pk_bf16_f32 v93, v200, v201
    v_cvt_pk_bf16_f32 v94, v202, v203
    v_cvt_pk_bf16_f32 v95, v204, v205
    v_mfma_f32_32x32x16_bf16 v[178:193], a[176:179], a[56:59], v[178:193]
    v_cvt_pk_bf16_f32 v152, v158, v159
    v_cvt_pk_bf16_f32 v153, v160, v161
    v_cvt_pk_bf16_f32 v250, v170, 0
    v_cvt_pk_bf16_f32 v174, v162, v163
    v_cvt_pk_bf16_f32 v175, v164, v165
    v_cvt_pk_bf16_f32 v176, v166, v167
    v_mfma_f32_32x32x16_bf16 v[178:193], a[180:183], a[60:63], v[178:193]
    v_cvt_pk_bf16_f32 v177, v168, v169
    v_permlane32_swap_b32 v112, v254
    v_max_f32 v112, v112, v254
    v_sub_f32 v114, v114, v112
    v_sub_f32 v115, v115, v112
    v_mfma_f32_32x32x16_bf16 v[178:193], a[184:187], a[64:67], v[178:193]
    v_sub_f32 v116, v116, v112
    v_sub_f32 v117, v117, v112
    v_sub_f32 v118, v118, v112
    v_sub_f32 v119, v119, v112
    v_sub_f32 v120, v120, v112
    v_sub_f32 v121, v121, v112
    v_mfma_f32_32x32x16_bf16 v[178:193], a[188:191], a[68:71], v[178:193]
    v_sub_f32 v122, v122, v112
    v_exp_f32 v122, v122
    v_sub_f32 v123, v123, v112
    v_exp_f32 v123, v123
    v_mfma_f32_32x32x16_bf16 v[154:169], v[96:99], v[146:149], 0
    v_sub_f32 v124, v124, v112
    v_exp_f32 v124, v124
    v_sub_f32 v125, v125, v112
    v_exp_f32 v125, v125
    v_mfma_f32_32x32x16_bf16 v[154:169], v[100:103], v[150:153], v[154:169]
    v_sub_f32 v126, v126, v112
    v_exp_f32 v126, v126
    v_sub_f32 v127, v127, v112
    v_exp_f32 v127, v127
    v_mfma_f32_32x32x16_bf16 v[154:169], v[104:107], v[174:177], v[154:169]
    v_sub_f32 v128, v128, v112
    v_exp_f32 v128, v128
    v_sub_f32 v129, v129, v112
    v_exp_f32 v129, v129
    v_mfma_f32_32x32x8_bf16 v[154:169], v[108:109], v[250:251], v[154:169]
    v_sub_f32 v130, v130, v112
    v_exp_f32 v130, v130
    v_sub_f32 v131, v131, v112
    v_exp_f32 v131, v131
    v_sub_f32_e64 v132, v132, v112
    v_cvt_pk_bf16_f32 v142, v130, v131
    v_exp_f32 v132, v132
    v_sub_f32 v133, v133, v112
    v_exp_f32 v133, v133
    v_sub_f32 v134, v134, v112
    v_cvt_pk_bf16_f32 v143, v132, v133
    v_exp_f32 v134, v134
    v_sub_f32 v135, v135, v112
    v_exp_f32 v135, v135
    v_sub_f32 v136, v136, v112
    v_cvt_pk_bf16_f32 v144, v134, v135
    v_exp_f32 v136, v136
    v_sub_f32 v137, v137, v112
    v_exp_f32 v137, v137
    v_sub_f32 v138, v138, v112
    v_cvt_pk_bf16_f32 v145, v136, v137
    v_exp_f32 v138, v138
    v_exp_f32 v114, v114
    v_cvt_pk_bf16_f32 v70, v138, 0
    v_exp_f32 v115, v115
    v_exp_f32 v116, v116
    v_cvt_pk_bf16_f32 v114, v114, v115
    v_exp_f32 v117, v117
    v_exp_f32 v118, v118
    v_cvt_pk_bf16_f32 v115, v116, v117
    v_exp_f32 v119, v119
    v_exp_f32 v120, v120
    v_cvt_pk_bf16_f32 v116, v118, v119
    v_cvt_pk_bf16_f32 v118, v122, v123
    v_cvt_pk_bf16_f32 v119, v124, v125
    v_exp_f32 v121, v121
    v_rcp_f32 v113, v166
    v_cvt_pk_bf16_f32 v117, v120, v121
    v_pk_mul_f32 v[154:155], v[154:155], v[112:113] op_sel:[0,1] op_sel_hi:[1,1]
    v_pk_mul_f32 v[156:157], v[156:157], v[112:113] op_sel:[0,1] op_sel_hi:[1,1]
    v_pk_mul_f32 v[158:159], v[158:159], v[112:113] op_sel:[0,1] op_sel_hi:[1,1]
    v_pk_mul_f32 v[160:161], v[160:161], v[112:113] op_sel:[0,1] op_sel_hi:[1,1]
    v_pk_mul_f32 v[162:163], v[162:163], v[112:113] op_sel:[0,1] op_sel_hi:[1,1]
    v_pk_mul_f32 v[164:165], v[164:165], v[112:113] op_sel:[0,1] op_sel_hi:[1,1]
    v_cvt_pk_bf16_f32 v120, v126, v127
    v_cvt_pk_bf16_f32 v121, v128, v129
    v_mfma_f32_32x32x16_bf16 v[122:137], v[96:99], v[114:117], 0
    v_cvt_pk_bf16_f32 v96, v210, v211
    v_cvt_pk_bf16_f32 v97, v212, v213
    v_cvt_pk_bf16_f32 v98, v214, v215
    v_cvt_pk_bf16_f32 v99, v216, v217
    v_cvt_pk_bf16_f32 v146, v154, v155
    v_cvt_pk_bf16_f32 v147, v156, v157
    v_mfma_f32_32x32x16_bf16 v[122:137], v[100:103], v[118:121], v[122:137]
    v_cvt_pk_bf16_f32 v100, v218, v219
    v_cvt_pk_bf16_f32 v101, v220, v221
    v_cvt_pk_bf16_f32 v102, v222, v223
    v_cvt_pk_bf16_f32 v103, v224, v225
    v_cvt_pk_bf16_f32 v148, v158, v159
    v_cvt_pk_bf16_f32 v149, v160, v161
    v_mfma_f32_32x32x16_bf16 v[122:137], v[104:107], v[142:145], v[122:137]
    v_cvt_pk_bf16_f32 v104, v178, v179
    v_cvt_pk_bf16_f32 v105, v180, v181
    v_cvt_pk_bf16_f32 v106, v182, v183
    v_cvt_pk_bf16_f32 v107, v184, v185
    v_cvt_pk_bf16_f32 v150, v162, v163
    v_cvt_pk_bf16_f32 v151, v164, v165
    v_mfma_f32_32x32x8_bf16 v[122:137], v[108:109], v[70:71], v[122:137]
    v_cvt_pk_bf16_f32 v108, v186, v187
    v_cvt_pk_bf16_f32 v109, v188, v189
    ds_write_b64 v55, v[146:147] offset:0
    ds_write_b64 v55, v[148:149] offset:16
    ds_write_b64 v55, v[150:151] offset:32
    v_cvt_pk_bf16_f32 v244, v228, v232
    buffer_store_dwordx3 v[242:244], v62, s[8:11], s43 offen sc1
    v_cvt_pk_bf16_f32 v248, v229, v233
    buffer_store_dwordx3 v[246:248], v63, s[8:11], s43 offen sc1
    v_readlane_b32 s43, v69, s36
    s_sub_u32 s46, s46, s44
    v_add_u32 v55, s47, v55
    v_rcp_f32 v112, v134
    v_add_u32 v52, s44, v52
    v_pk_mul_f32 v[122:123], v[122:123], v[112:113] op_sel_hi:[1,0]
    v_pk_mul_f32 v[124:125], v[124:125], v[112:113] op_sel_hi:[1,0]
    v_pk_mul_f32 v[126:127], v[126:127], v[112:113] op_sel_hi:[1,0]
    v_pk_mul_f32 v[128:129], v[128:129], v[112:113] op_sel_hi:[1,0]
    v_pk_mul_f32 v[130:131], v[130:131], v[112:113] op_sel_hi:[1,0]
    v_pk_mul_f32 v[132:133], v[132:133], v[112:113] op_sel_hi:[1,0]
    v_cvt_pk_bf16_f32 v114, v122, v123
    v_cvt_pk_bf16_f32 v115, v124, v125
    v_cvt_pk_bf16_f32 v116, v126, v127
    v_cvt_pk_bf16_f32 v117, v128, v129
    v_cvt_pk_bf16_f32 v118, v130, v131
    v_cvt_pk_bf16_f32 v119, v132, v133
    ds_write_b64 v54, v[114:115] offset:0
    ds_write_b64 v54, v[116:117] offset:16
    ds_write_b64 v54, v[118:119] offset:32
    v_add_u32 v54, s47, v54
    s_sub_u32 s47, 0, s47
    v_add_u32 v53, s44, v53
    s_sub_u32 s44, 0, s44
    s_waitcnt vmcnt(4) lgkmcnt(0)
    s_barrier
    s_add_u32 s53, s33, 1
    s_cmp_lt_u32 s53, s34
    s_cbranch_scc1 S_LOOP
    v_mfma_f32_32x32x8_bf16 v[146:161], a[204:205], a[210:211], v[26:41]
    s_add_u32 s33, s33, 1
    s_sub_u32 s44, 0, s44
    s_add_u32 s35, s35, 1
    v_readlane_b32 s42, v69, s35
    s_add_u32 s36, s36, 1
    s_and_b32 s36, s36, 63
    v_mfma_f32_32x32x16_bf16 v[146:161], v[84:87], v[78:81], v[146:161]
    v_mfma_f32_32x32x8_bf16 v[146:161], v[88:89], v[82:83], v[146:161]
    v_mfma_f32_32x32x8_bf16 v[162:177], a[206:207], a[210:211], v[42:57]
    v_mfma_f32_32x32x16_bf16 v[162:177], v[90:93], v[78:81], v[162:177]
    v_mfma_f32_32x32x8_bf16 v[162:177], v[94:95], v[82:83], v[162:177]
    s_nop 4
    v_add_u32 v56, s47, v56
    v_mfma_f32_32x32x8_bf16 v[114:129], a[204:205], a[208:209], v[0:15]
    ds_read_b128 a[192:195], v56 offset:0
    ds_read_b128 a[196:199], v56 offset:64
    ds_read_b128 a[200:203], v56 offset:128
    v_mfma_f32_32x32x16_bf16 v[114:129], v[84:87], v[72:75], v[114:129]
    v_max3_f32 v113, v146, v147, v148
    v_mfma_f32_32x32x8_bf16 v[114:129], v[88:89], v[76:77], v[114:129]
    v_max3_f32 v113, v113, v149, v150
    v_max3_f32 v113, v113, v151, v152
    v_max3_f32 v113, v113, v153, v154
    v_max3_f32 v113, v113, v155, v156
    v_max3_f32 v113, v113, v157, v158
    v_mfma_f32_32x32x8_bf16 v[130:145], a[206:207], a[208:209], v[16:31]
    v_max3_f32 v113, v113, v159, v160
    v_max3_f32 v113, v113, v161, v162
    v_max3_f32 v113, v113, v163, v164
    v_max3_f32 v113, v113, v165, v166
    v_max3_f32 v113, v113, v167, v168
    v_max3_f32 v113, v113, v169, v170
    v_mfma_f32_32x32x16_bf16 v[130:145], v[90:93], v[72:75], v[130:145]
    v_mov_b32 v255, v113
    v_max3_f32 v112, v114, v115, v116
    v_max3_f32 v112, v112, v117, v118
    v_permlane32_swap_b32 v113, v255
    v_max_f32 v113, v113, v255
    v_mfma_f32_32x32x8_bf16 v[130:145], v[94:95], v[76:77], v[130:145]
    v_sub_f32 v146, v146, v113
    v_sub_f32 v147, v147, v113
    v_sub_f32 v148, v148, v113
    v_sub_f32 v149, v149, v113
    v_exp_f32 v146, v146
    v_exp_f32 v147, v147
    v_sub_f32 v150, v150, v113
    v_sub_f32 v151, v151, v113
    v_sub_f32 v152, v152, v113
    v_sub_f32 v153, v153, v113
    v_exp_f32 v148, v148
    v_exp_f32 v149, v149
    v_cvt_pk_bf16_f32 v146, v146, v147
    v_sub_f32 v154, v154, v113
    v_sub_f32 v155, v155, v113
    v_sub_f32 v156, v156, v113
    v_sub_f32 v157, v157, v113
    v_sub_f32 v158, v158, v113
    v_sub_f32 v159, v159, v113
    v_sub_f32 v160, v160, v113
    v_sub_f32 v161, v161, v113
    v_sub_f32 v162, v162, v113
    v_sub_f32 v163, v163, v113
    v_sub_f32 v164, v164, v113
    v_sub_f32 v165, v165, v113
    v_sub_f32 v166, v166, v113
    v_sub_f32 v167, v167, v113
    s_waitcnt lgkmcnt(0)
    v_mfma_f32_16x16x32_bf16 v[210:213], a[192:195], a[72:75], 0
    v_sub_f32 v168, v168, v113
    v_sub_f32 v169, v169, v113
    v_mfma_f32_16x16x32_bf16 v[210:213], a[196:199], a[96:99], v[210:213]
    v_sub_f32 v170, v170, v113
    v_cvt_pk_bf16_f32 v147, v148, v149
    v_mfma_f32_16x16x32_bf16 v[210:213], a[200:203], a[120:123], v[210:213]
    v_exp_f32 v150, v150
    v_mfma_f32_16x16x32_bf16 v[214:217], a[192:195], a[76:79], 0
    v_exp_f32 v151, v151
    v_mfma_f32_16x16x32_bf16 v[214:217], a[196:199], a[100:103], v[214:217]
    v_exp_f32 v152, v152
    v_mfma_f32_16x16x32_bf16 v[214:217], a[200:203], a[124:127], v[214:217]
    v_exp_f32 v153, v153
    v_mfma_f32_16x16x32_bf16 v[218:221], a[192:195], a[80:83], 0
    v_max3_f32 v112, v112, v119, v120
    v_max3_f32 v112, v112, v121, v122
    v_mfma_f32_16x16x32_bf16 v[218:221], a[196:199], a[104:107], v[218:221]
    v_max3_f32 v112, v112, v123, v124
    v_max3_f32 v112, v112, v125, v126
    v_mfma_f32_16x16x32_bf16 v[218:221], a[200:203], a[128:131], v[218:221]
    v_max3_f32 v112, v112, v127, v128
    v_max3_f32 v112, v112, v129, v130
    v_mfma_f32_16x16x32_bf16 v[222:225], a[192:195], a[84:87], 0
    v_max3_f32 v112, v112, v131, v132
    v_max3_f32 v112, v112, v133, v134
    v_mfma_f32_16x16x32_bf16 v[222:225], a[196:199], a[108:111], v[222:225]
    v_max3_f32 v112, v112, v135, v136
    v_max3_f32 v112, v112, v137, v138
    v_mfma_f32_16x16x32_bf16 v[222:225], a[200:203], a[132:135], v[222:225]
    v_exp_f32 v154, v154
    v_mfma_f32_16x16x32_bf16 v[226:229], a[192:195], a[88:91], 0
    v_exp_f32 v155, v155
    v_mfma_f32_16x16x32_bf16 v[226:229], a[196:199], a[112:115], v[226:229]
    v_exp_f32 v156, v156
    v_mfma_f32_16x16x32_bf16 v[226:229], a[200:203], a[136:139], v[226:229]
    v_exp_f32 v157, v157
    v_mfma_f32_16x16x32_bf16 v[230:233], a[192:195], a[92:95], 0
    v_exp_f32 v158, v158
    v_mfma_f32_16x16x32_bf16 v[230:233], a[196:199], a[116:119], v[230:233]
    v_exp_f32 v159, v159
    v_mfma_f32_16x16x32_bf16 v[230:233], a[200:203], a[140:143], v[230:233]
    v_exp_f32 v160, v160
    v_exp_f32 v161, v161
    v_exp_f32 v162, v162
    v_exp_f32 v163, v163
    v_exp_f32 v164, v164
    v_exp_f32 v165, v165
    v_exp_f32 v166, v166
    v_cvt_pk_bf16_f32 v148, v150, v151
    v_pk_mul_f32 v[234:235], v[210:211], v[210:211]
    v_pk_mul_f32 v[236:237], v[212:213], v[212:213]
    v_pk_fma_f32 v[234:235], v[214:215], v[214:215], v[234:235]
    v_pk_fma_f32 v[236:237], v[216:217], v[216:217], v[236:237]
    v_pk_fma_f32 v[234:235], v[218:219], v[218:219], v[234:235]
    v_pk_fma_f32 v[236:237], v[220:221], v[220:221], v[236:237]
    v_pk_fma_f32 v[234:235], v[222:223], v[222:223], v[234:235]
    v_pk_fma_f32 v[236:237], v[224:225], v[224:225], v[236:237]
    v_pk_fma_f32 v[234:235], v[226:227], v[226:227], v[234:235]
    v_pk_fma_f32 v[236:237], v[228:229], v[228:229], v[236:237]
    v_pk_fma_f32 v[234:235], v[230:231], v[230:231], v[234:235]
    v_pk_fma_f32 v[236:237], v[232:233], v[232:233], v[236:237]
    v_exp_f32 v167, v167
    v_exp_f32 v168, v168
    v_add_f32_dpp v242, v234, v234 row_ror:8 row_mask:0xf bank_mask:0x3
    v_add_f32_dpp v243, v236, v236 row_ror:8 row_mask:0xf bank_mask:0x3
    v_exp_f32 v169, v169
    v_add_f32_dpp v242, v235, v235 row_ror:8 row_mask:0xf bank_mask:0xc
    v_add_f32_dpp v243, v237, v237 row_ror:8 row_mask:0xf bank_mask:0xc
    v_exp_f32 v170, v170
    v_add_f32_dpp v244, v242, v242 row_half_mirror row_mask:0xf bank_mask:0x5
    v_cvt_pk_bf16_f32 v149, v152, v153
    v_mov_b32 v254, v112
    v_add_f32_dpp v244, v243, v243 row_half_mirror row_mask:0xf bank_mask:0xa
    v_cvt_pk_bf16_f32 v150, v154, v155
    v_permlane32_swap_b32 v112, v254
    v_add_f32_dpp v242, v244, v244 quad_perm:[1,0,3,2] row_mask:0xf bank_mask:0xf
    v_max_f32 v112, v112, v254
    v_sub_f32 v114, v114, v112
    v_add_f32_dpp v244, v242, v242 quad_perm:[2,3,0,1] row_mask:0xf bank_mask:0xf
    v_add_f32 v244, 0x3a7ba882, v244
    v_sub_f32 v115, v115, v112
    v_sub_f32 v116, v116, v112
    v_sub_f32 v117, v117, v112
    v_sub_f32 v118, v118, v112
    v_sub_f32 v119, v119, v112
    v_sub_f32 v120, v120, v112
    v_sub_f32 v121, v121, v112
    v_sub_f32 v122, v122, v112
    v_sub_f32 v123, v123, v112
    v_sub_f32 v124, v124, v112
    v_sub_f32 v125, v125, v112
    v_sub_f32 v126, v126, v112
    v_sub_f32 v127, v127, v112
    v_sub_f32 v128, v128, v112
    v_sub_f32 v129, v129, v112
    v_sub_f32 v130, v130, v112
    v_sub_f32 v131, v131, v112
    v_sub_f32 v132, v132, v112
    v_sub_f32 v133, v133, v112
    v_sub_f32 v134, v134, v112
    v_sub_f32 v135, v135, v112
    v_sub_f32 v136, v136, v112
    v_sub_f32 v137, v137, v112
    v_sub_f32 v138, v138, v112
    v_rsq_f32 v244, v244
    v_cvt_pk_bf16_f32 v151, v156, v157
    v_mul_f32 v244, 0x411cc471, v244
    v_cvt_pk_bf16_f32 v152, v158, v159
    v_cvt_pk_bf16_f32 v153, v160, v161
    v_cvt_pk_bf16_f32 v250, v170, 0
    v_cvt_pk_bf16_f32 v174, v162, v163
    v_cvt_pk_bf16_f32 v175, v164, v165
    v_cvt_pk_bf16_f32 v176, v166, v167
    v_cvt_pk_bf16_f32 v177, v168, v169
    v_mfma_f32_32x32x16_bf16 v[154:169], v[96:99], v[146:149], 0
    v_exp_f32 v114, v114
    v_exp_f32 v115, v115
    v_exp_f32 v116, v116
    v_mfma_f32_32x32x16_bf16 v[154:169], v[100:103], v[150:153], v[154:169]
    v_cvt_pk_bf16_f32 v114, v114, v115
    v_exp_f32 v117, v117
    v_exp_f32 v118, v118
    v_cvt_pk_bf16_f32 v115, v116, v117
    v_mfma_f32_32x32x16_bf16 v[154:169], v[104:107], v[174:177], v[154:169]
    v_exp_f32 v119, v119
    v_exp_f32 v120, v120
    v_cvt_pk_bf16_f32 v116, v118, v119
    v_mov_b32_dpp v234, v244 row_newbcast:0 row_mask:0xf bank_mask:0xf
    v_mfma_f32_32x32x8_bf16 v[154:169], v[108:109], v[250:251], v[154:169]
    v_exp_f32 v121, v121
    v_exp_f32 v122, v122
    v_cvt_pk_bf16_f32 v117, v120, v121
    v_exp_f32 v123, v123
    v_exp_f32 v124, v124
    v_cvt_pk_bf16_f32 v118, v122, v123
    v_exp_f32 v125, v125
    v_mov_b32_dpp v235, v244 row_newbcast:8 row_mask:0xf bank_mask:0xf
    v_cvt_pk_bf16_f32 v119, v124, v125
    v_mov_b32_dpp v236, v244 row_newbcast:4 row_mask:0xf bank_mask:0xf
    v_mov_b32_dpp v237, v244 row_newbcast:12 row_mask:0xf bank_mask:0xf
    v_pk_mul_f32 v[210:211], v[210:211], v[234:235]
    v_pk_mul_f32 v[214:215], v[214:215], v[234:235]
    v_pk_mul_f32 v[218:219], v[218:219], v[234:235]
    v_pk_mul_f32 v[222:223], v[222:223], v[234:235]
    v_pk_mul_f32 v[226:227], v[226:227], v[234:235]
    v_pk_mul_f32 v[230:231], v[230:231], v[234:235]
    v_pk_mul_f32 v[212:213], v[212:213], v[236:237]
    v_pk_mul_f32 v[216:217], v[216:217], v[236:237]
    v_pk_mul_f32 v[220:221], v[220:221], v[236:237]
    v_pk_mul_f32 v[224:225], v[224:225], v[236:237]
    v_pk_mul_f32 v[228:229], v[228:229], v[236:237]
    v_pk_mul_f32 v[232:233], v[232:233], v[236:237]
    v_exp_f32 v126, v126
    v_exp_f32 v127, v127
    v_exp_f32 v128, v128
    v_exp_f32 v129, v129
    v_exp_f32 v130, v130
    v_exp_f32 v131, v131
    v_exp_f32 v132, v132
    v_exp_f32 v133, v133
    v_exp_f32 v134, v134
    v_exp_f32 v135, v135
    v_exp_f32 v136, v136
    v_exp_f32 v137, v137
    v_exp_f32 v138, v138
    v_cvt_pk_bf16_f32 v120, v126, v127
    v_cvt_pk_bf16_f32 v70, v138, 0
    v_cvt_pk_bf16_f32 v121, v128, v129
    v_cvt_pk_bf16_f32 v142, v130, v131
    v_cvt_pk_bf16_f32 v143, v132, v133
    v_cvt_pk_bf16_f32 v144, v134, v135
    v_cvt_pk_bf16_f32 v145, v136, v137
    v_mfma_f32_32x32x16_bf16 v[122:137], v[96:99], v[114:117], 0
    v_cvt_pk_bf16_f32 v242, v210, v214
    v_cvt_pk_bf16_f32 v243, v218, v222
    v_cvt_pk_bf16_f32 v244, v226, v230
    v_cvt_pk_bf16_f32 v246, v211, v215
    v_cvt_pk_bf16_f32 v247, v219, v223
    v_cvt_pk_bf16_f32 v248, v227, v231
    v_mfma_f32_32x32x16_bf16 v[122:137], v[100:103], v[118:121], v[122:137]
    v_rcp_f32 v113, v166
    buffer_store_dwordx3 v[242:244], v60, s[8:11], s43 offen sc1
    v_pk_mul_f32 v[154:155], v[154:155], v[112:113] op_sel:[0,1] op_sel_hi:[1,1]
    v_pk_mul_f32 v[156:157], v[156:157], v[112:113] op_sel:[0,1] op_sel_hi:[1,1]
    v_pk_mul_f32 v[158:159], v[158:159], v[112:113] op_sel:[0,1] op_sel_hi:[1,1]
    v_pk_mul_f32 v[160:161], v[160:161], v[112:113] op_sel:[0,1] op_sel_hi:[1,1]
    v_pk_mul_f32 v[162:163], v[162:163], v[112:113] op_sel:[0,1] op_sel_hi:[1,1]
    v_pk_mul_f32 v[164:165], v[164:165], v[112:113] op_sel:[0,1] op_sel_hi:[1,1]
    v_mfma_f32_32x32x16_bf16 v[122:137], v[104:107], v[142:145], v[122:137]
    v_cvt_pk_bf16_f32 v242, v212, v216
    v_cvt_pk_bf16_f32 v243, v220, v224
    v_cvt_pk_bf16_f32 v244, v228, v232
    v_cvt_pk_bf16_f32 v146, v154, v155
    v_cvt_pk_bf16_f32 v147, v156, v157
    v_cvt_pk_bf16_f32 v148, v158, v159
    v_mfma_f32_32x32x8_bf16 v[122:137], v[108:109], v[70:71], v[122:137]
    buffer_store_dwordx3 v[246:248], v61, s[8:11], s43 offen sc1
    buffer_store_dwordx3 v[242:244], v62, s[8:11], s43 offen sc1
    v_cvt_pk_bf16_f32 v149, v160, v161
    v_cvt_pk_bf16_f32 v246, v213, v217
    v_cvt_pk_bf16_f32 v247, v221, v225
    v_cvt_pk_bf16_f32 v248, v229, v233
    buffer_store_dwordx3 v[246:248], v63, s[8:11], s43 offen sc1
    v_readlane_b32 s43, v69, s36
    v_cvt_pk_bf16_f32 v150, v162, v163
    v_cvt_pk_bf16_f32 v151, v164, v165
    ds_write_b64 v55, v[146:147] offset:0
    ds_write_b64 v55, v[148:149] offset:16
    ds_write_b64 v55, v[150:151] offset:32
    v_rcp_f32 v112, v134
    v_add_u32 v55, s47, v55
    v_pk_mul_f32 v[122:123], v[122:123], v[112:113] op_sel_hi:[1,0]
    v_pk_mul_f32 v[124:125], v[124:125], v[112:113] op_sel_hi:[1,0]
    v_pk_mul_f32 v[126:127], v[126:127], v[112:113] op_sel_hi:[1,0]
    v_pk_mul_f32 v[128:129], v[128:129], v[112:113] op_sel_hi:[1,0]
    v_pk_mul_f32 v[130:131], v[130:131], v[112:113] op_sel_hi:[1,0]
    v_pk_mul_f32 v[132:133], v[132:133], v[112:113] op_sel_hi:[1,0]
    v_cvt_pk_bf16_f32 v114, v122, v123
    v_cvt_pk_bf16_f32 v115, v124, v125
    v_cvt_pk_bf16_f32 v116, v126, v127
    v_cvt_pk_bf16_f32 v117, v128, v129
    v_cvt_pk_bf16_f32 v118, v130, v131
    v_cvt_pk_bf16_f32 v119, v132, v133
    ds_write_b64 v54, v[114:115] offset:0
    ds_write_b64 v54, v[116:117] offset:16
    ds_write_b64 v54, v[118:119] offset:32
    v_add_u32 v54, s47, v54
    s_sub_u32 s47, 0, s47
    s_waitcnt vmcnt(4) lgkmcnt(0)
    s_barrier
L_TAIL:
    v_add_u32 v56, s47, v56
    ds_read_b128 a[192:195], v56 offset:0
    ds_read_b128 a[196:199], v56 offset:64
    ds_read_b128 a[200:203], v56 offset:128
    v_accvgpr_read_b32 v60, a212
    v_accvgpr_read_b32 v61, a213
    v_accvgpr_read_b32 v62, a214
    v_accvgpr_read_b32 v63, a215
    s_waitcnt lgkmcnt(2)
    v_mfma_f32_16x16x32_bf16 v[210:213], a[192:195], a[72:75], 0
    s_waitcnt lgkmcnt(1)
    v_mfma_f32_16x16x32_bf16 v[210:213], a[196:199], a[96:99], v[210:213]
    s_waitcnt lgkmcnt(0)
    v_mfma_f32_16x16x32_bf16 v[210:213], a[200:203], a[120:123], v[210:213]
    v_mfma_f32_16x16x32_bf16 v[214:217], a[192:195], a[76:79], 0
    v_mfma_f32_16x16x32_bf16 v[214:217], a[196:199], a[100:103], v[214:217]
    v_mfma_f32_16x16x32_bf16 v[214:217], a[200:203], a[124:127], v[214:217]
    v_mfma_f32_16x16x32_bf16 v[218:221], a[192:195], a[80:83], 0
    v_mfma_f32_16x16x32_bf16 v[218:221], a[196:199], a[104:107], v[218:221]
    v_mfma_f32_16x16x32_bf16 v[218:221], a[200:203], a[128:131], v[218:221]
    v_mfma_f32_16x16x32_bf16 v[222:225], a[192:195], a[84:87], 0
    v_mfma_f32_16x16x32_bf16 v[222:225], a[196:199], a[108:111], v[222:225]
    v_mfma_f32_16x16x32_bf16 v[222:225], a[200:203], a[132:135], v[222:225]
    v_mfma_f32_16x16x32_bf16 v[226:229], a[192:195], a[88:91], 0
    v_mfma_f32_16x16x32_bf16 v[226:229], a[196:199], a[112:115], v[226:229]
    v_mfma_f32_16x16x32_bf16 v[226:229], a[200:203], a[136:139], v[226:229]
    v_mfma_f32_16x16x32_bf16 v[230:233], a[192:195], a[92:95], 0
    v_mfma_f32_16x16x32_bf16 v[230:233], a[196:199], a[116:119], v[230:233]
    v_mfma_f32_16x16x32_bf16 v[230:233], a[200:203], a[140:143], v[230:233]
    v_pk_mul_f32 v[234:235], v[210:211], v[210:211]
    v_pk_mul_f32 v[236:237], v[212:213], v[212:213]
    v_pk_fma_f32 v[234:235], v[214:215], v[214:215], v[234:235]
    v_pk_fma_f32 v[236:237], v[216:217], v[216:217], v[236:237]
    v_pk_fma_f32 v[234:235], v[218:219], v[218:219], v[234:235]
    v_pk_fma_f32 v[236:237], v[220:221], v[220:221], v[236:237]
    v_pk_fma_f32 v[234:235], v[222:223], v[222:223], v[234:235]
    v_pk_fma_f32 v[236:237], v[224:225], v[224:225], v[236:237]
    v_pk_fma_f32 v[234:235], v[226:227], v[226:227], v[234:235]
    v_pk_fma_f32 v[236:237], v[228:229], v[228:229], v[236:237]
    v_pk_fma_f32 v[234:235], v[230:231], v[230:231], v[234:235]
    v_pk_fma_f32 v[236:237], v[232:233], v[232:233], v[236:237]
    s_nop 0
    v_add_f32_dpp v242, v234, v234 row_ror:8 row_mask:0xf bank_mask:0x3
    v_add_f32_dpp v243, v236, v236 row_ror:8 row_mask:0xf bank_mask:0x3
    s_nop 0
    v_add_f32_dpp v242, v235, v235 row_ror:8 row_mask:0xf bank_mask:0xc
    v_add_f32_dpp v243, v237, v237 row_ror:8 row_mask:0xf bank_mask:0xc
    s_nop 0
    v_add_f32_dpp v244, v242, v242 row_half_mirror row_mask:0xf bank_mask:0x5
    s_nop 1
    v_add_f32_dpp v244, v243, v243 row_half_mirror row_mask:0xf bank_mask:0xa
    s_nop 1
    v_add_f32_dpp v242, v244, v244 quad_perm:[1,0,3,2] row_mask:0xf bank_mask:0xf
    s_nop 1
    v_add_f32_dpp v244, v242, v242 quad_perm:[2,3,0,1] row_mask:0xf bank_mask:0xf
    v_add_f32 v244, 0x3a7ba882, v244
    v_rsq_f32 v244, v244
    s_nop 0
    v_mul_f32 v244, 0x411cc471, v244
    s_nop 1
    v_mov_b32_dpp v234, v244 row_newbcast:0 row_mask:0xf bank_mask:0xf
    v_mov_b32_dpp v235, v244 row_newbcast:8 row_mask:0xf bank_mask:0xf
    v_mov_b32_dpp v236, v244 row_newbcast:4 row_mask:0xf bank_mask:0xf
    v_mov_b32_dpp v237, v244 row_newbcast:12 row_mask:0xf bank_mask:0xf
    v_pk_mul_f32 v[210:211], v[210:211], v[234:235]
    v_pk_mul_f32 v[214:215], v[214:215], v[234:235]
    v_pk_mul_f32 v[218:219], v[218:219], v[234:235]
    v_pk_mul_f32 v[222:223], v[222:223], v[234:235]
    v_pk_mul_f32 v[226:227], v[226:227], v[234:235]
    v_pk_mul_f32 v[230:231], v[230:231], v[234:235]
    v_pk_mul_f32 v[212:213], v[212:213], v[236:237]
    v_pk_mul_f32 v[216:217], v[216:217], v[236:237]
    v_pk_mul_f32 v[220:221], v[220:221], v[236:237]
    v_pk_mul_f32 v[224:225], v[224:225], v[236:237]
    v_pk_mul_f32 v[228:229], v[228:229], v[236:237]
    v_pk_mul_f32 v[232:233], v[232:233], v[236:237]
    v_cvt_pk_bf16_f32 v242, v210, v214
    v_cvt_pk_bf16_f32 v243, v218, v222
    v_cvt_pk_bf16_f32 v244, v226, v230
    buffer_store_dwordx3 v[242:244], v60, s[8:11], s43 offen sc1
    v_cvt_pk_bf16_f32 v246, v211, v215
    v_cvt_pk_bf16_f32 v247, v219, v223
    v_cvt_pk_bf16_f32 v248, v227, v231
    buffer_store_dwordx3 v[246:248], v61, s[8:11], s43 offen sc1
    v_cvt_pk_bf16_f32 v242, v212, v216
    v_cvt_pk_bf16_f32 v243, v220, v224
    v_cvt_pk_bf16_f32 v244, v228, v232
    buffer_store_dwordx3 v[242:244], v62, s[8:11], s43 offen sc1
    v_cvt_pk_bf16_f32 v246, v213, v217
    v_cvt_pk_bf16_f32 v247, v221, v225
    v_cvt_pk_bf16_f32 v248, v229, v233
    buffer_store_dwordx3 v[246:248], v63, s[8:11], s43 offen sc1
L_END:
    s_endpgm
F1_SWAP:
    s_nop 15
    s_waitcnt lgkmcnt(0)
    v_accvgpr_read_b32 v57, a216
    v_accvgpr_read_b32 v58, a217
    v_accvgpr_read_b32 v59, a218
    s_nop 15
    s_branch F1_SWAP_RET
S1_SWAP:
    s_nop 15
    s_waitcnt lgkmcnt(0)
    v_accvgpr_read_b32 v57, a216
    v_accvgpr_read_b32 v58, a217
    v_accvgpr_read_b32 v59, a218
    s_nop 15
    s_branch S1_SWAP_RET
L_CODE_END:
.section .rodata,"a"
.p2align 6
.amdhsa_kernel standalone__window_attn_swin_v2__vision_kernel
  .amdhsa_next_free_vgpr 512
  .amdhsa_next_free_sgpr 102
  .amdhsa_accum_offset 256
  .amdhsa_group_segment_fixed_size 0
  .amdhsa_kernarg_size 96
  .amdhsa_user_sgpr_count 2
  .amdhsa_user_sgpr_kernarg_segment_ptr 1
  .amdhsa_system_sgpr_workgroup_id_x 1
.end_amdhsa_kernel
```
